```python
import torch

def _softmax(x, axis=-1):
    return torch.softmax(x, dim=axis)
def _gelu(x):
    return torch.nn.functional.gelu(x, approximate="tanh")
def _silu(x):
    return torch.nn.functional.silu(x)
def _sigmoid(x):
    return torch.sigmoid(x)
def _layernorm(x, axis=-1, eps=1e-5):
    m = x.mean(dim=axis, keepdim=True)
    v = x.var(dim=axis, keepdim=True, unbiased=False)
    return (x - m) / torch.sqrt(v + eps)
def _scatter_add(tgt, idx, src, axis=0):
    return tgt.clone().index_add_(axis, idx, src)
def _segment_sum(src, seg, n):
    out = torch.zeros((n,) + src.shape[1:], dtype=src.dtype)
    return out.index_add_(0, seg, src)
def _pad(x, pw):
    flat = tuple(v for pair in reversed(pw) for v in pair)
    return torch.nn.functional.pad(x, flat)

kernel_name = 'recurrent_scan__sliding_block_cached__glu_gated_reglu__decode'

def setup_inputs():

    _w = (lambda a: (lambda t: t.to(torch.bfloat16) if t.is_floating_point() else t)(torch.as_tensor(a)))
    def _A_setup():
        B, Sq, D = 1, 1, 448
        Hq, Hkv, Sk, Dh = 16, 8, 65536, 256
        assert Hq % Hkv == 0, (Hq, Hkv)
        return {
            "x": _w((lambda *s: torch.randn(*s, dtype=torch.bfloat16) * 0.2)(B, Sq, D)),
            "k_cache": _w((lambda *s: torch.randn(*s, dtype=torch.bfloat16) * 1.6)(B, Hkv, Sk, Dh)),
            "v_cache": _w((lambda *s: torch.randn(*s, dtype=torch.bfloat16) * 1.6)(B, Hkv, Sk, Dh)),
            "wq": _w((lambda *s: torch.randn(*s, dtype=torch.bfloat16) * 1.6)(D, Hq * Dh) * (D ** -0.5)),
            "wo": _w((lambda *s: torch.randn(*s, dtype=torch.bfloat16) * 1.6)(Hq * Dh, D) * ((Hq * Dh) ** -0.5)),
        }
    _A_in = _A_setup()

    def _B_setup():
        B, S, D, F = 1, 1, 448, 1792
        return {
            "x": _w((lambda *s: torch.randn(*s, dtype=torch.bfloat16) * 0.2)(B, S, D)),
            "W_gate": _w((lambda *s: torch.randn(*s, dtype=torch.bfloat16) * 0.8)(D, F) * (2.0 / D) ** 0.5),
            "W_up": _w((lambda *s: torch.randn(*s, dtype=torch.bfloat16) * 0.8)(D, F) * (2.0 / D) ** 0.5),
            "W_down": _w((lambda *s: torch.randn(*s, dtype=torch.bfloat16) * 0.8)(F, D) * (1.0 / F) ** 0.5),
        }
    _B_in = _B_setup()

    return {
        "A_x": _A_in["x"],
        "A_k_cache": _A_in["k_cache"],
        "A_v_cache": _A_in["v_cache"],
        "A_wq": _A_in["wq"],
        "A_wo": _A_in["wo"],
        "B_x": _B_in["x"],
        "B_W_gate": _B_in["W_gate"],
        "B_W_up": _B_in["W_up"],
        "B_W_down": _B_in["W_down"],
    }

def reference(A_x, A_k_cache, A_v_cache, A_wq, A_wo, B_x, B_W_gate, B_W_up, B_W_down):
    def _A_ref(x, k_cache, v_cache, wq, wo):
        B, Sq, D = x.shape
        Hq, Dh = 16, 256
        Hkv, Sk = k_cache.shape[1], k_cache.shape[2]
        W = min(4096, max(256, Sk // 4))
        rep = Hq // Hkv
        q = (lambda x, *d: x.permute(*d))((x @ wq).reshape(B, Sq, Hq, Dh), 0, 2, 1, 3)
        k = (lambda x, n, axis: torch.repeat_interleave(x, n, dim=axis))(k_cache[:, :, Sk - W:, :], rep, axis=1)
        v = (lambda x, n, axis: torch.repeat_interleave(x, n, dim=axis))(v_cache[:, :, Sk - W:, :], rep, axis=1)
        scores = torch.einsum("bhqd,bhkd->bhqk", q, k) * (Dh ** -0.5)
        p = _softmax(scores, axis=-1)
        o = torch.einsum("bhqk,bhkd->bhqd", p, v)
        return (lambda x, *d: x.permute(*d))(o, 0, 2, 1, 3).reshape(B, Sq, Hq * Dh) @ wo

    def _B_ref(x, W_gate, W_up, W_down):
        gate = torch.einsum("bsd,df->bsf", x, W_gate)
        up = torch.einsum("bsd,df->bsf", x, W_up)
        gate = gate * (lambda x, dt: x.to(dt))(gate > 0, gate.dtype)
        h = gate * up
        return torch.einsum("bsf,fd->bsd", h, W_down)

    x = A_x
    xn = _layernorm(x, axis=-1)
    s = _A_ref(xn, A_k_cache, A_v_cache, A_wq, A_wo)
    g = _silu(_B_ref(xn, B_W_gate, B_W_up, B_W_down))
    return x + s * g
```

```asm
; @launch grid=(256,1,1) block=(640,1,1) lds=22528
.amdgcn_target "amdgcn-amd-amdhsa--gfx950"
.text
.globl recurrent_scan__sliding_block_cached__glu_gated_reglu__decode_kernel
.p2align 8
.type recurrent_scan__sliding_block_cached__glu_gated_reglu__decode_kernel,@function
recurrent_scan__sliding_block_cached__glu_gated_reglu__decode_kernel:
L_start:
    s_load_dwordx16 s[4:19], s[0:1], 0
    s_load_dwordx8 s[20:27], s[0:1], 64
    v_lshrrev_b32 v1, 6, v0
    s_cmpk_ge_u32 s2, 256
    s_cbranch_scc1 L_end
    v_readfirstlane_b32 s30, v1
    v_and_b32 v0, 63, v0
    s_add_u32 s28, s2, 7
    s_and_b32 s28, s28, 7
    s_lshr_b32 s29, s2, 3
    s_cmp_eq_u32 s30, 8
    s_cbranch_scc1 L_h0i
    s_cmp_eq_u32 s30, 9
    s_cbranch_scc0 L_att
    s_getpc_b64 s[48:49]
L_pc:
    v_lshlrev_b32 v2, 7, v0
    global_load_dword v4, v2, s[48:49] offset:192
    s_mov_b64 exec, 0
    s_branch L_pad1
L_att:
    s_add_u32 s58, s30, s29
    s_and_b32 s58, s58, 7
    s_lshr_b32 s59, s29, 2
    s_xor_b32 s59, s59, s58
    s_lshl4_add_u32 s53, s28, 15
    s_lshl4_add_u32 s53, s53, s59
    s_and_b32 s59, s29, 3
    s_mul_i32 s59, s59, 9
    s_and_b32 s59, s59, 17
    s_lshl1_add_u32 s59, s58, s59
    s_lshl_b32 s53, s53, 6
    s_add_u32 s53, s53, s59
    s_lshl_b32 s53, s53, 11
    v_lshrrev_b32 v1, 4, v0
    v_bfe_u32 v2, v0, 2, 2
    v_and_b32 v3, 3, v0
    v_lshlrev_b32 v93, 9, v2
    v_lshl_add_u32 v93, v1, 6, v93
    v_lshl_add_u32 v93, v3, 4, v93
    s_mov_b32 s42, 1116160
    s_mov_b32 s43, 0x20000
    s_waitcnt lgkmcnt(0)
    s_add_u32 s40, s6, s53
    s_addc_u32 s41, s7, 0
    buffer_load_dwordx4 v[4:7], v93, s[40:43], 0 offen offset:0 nt
    s_barrier
    s_branch L_att2
    .p2align 8
L_att2:
    s_lshl_b32 s57, 1, 16
    s_mov_b32 s54, 1048576
    s_mov_b32 s25, 1114112
    buffer_load_dwordx4 v[8:11], v93, s[40:43], 0 offen offset:256 nt
    buffer_load_dwordx4 v[12:15], v93, s[40:43], s57 offen offset:0 nt
    s_mov_b32 s36, s26
    s_mov_b32 s37, s27
    s_mov_b32 s38, 2097152
    s_mov_b32 s39, 0x20000
    s_mov_b32 s60, 4294966272
    s_add_u32 s44, s8, s53
    s_addc_u32 s45, s9, 0
    s_mov_b32 s46, 1116160
    s_mov_b32 s47, 0x20000
    s_mov_b32 s61, 1035512379
    v_lshlrev_b32 v133, 11, v2
    v_lshl_add_u32 v133, v1, 4, v133
    v_lshl_add_u32 v133, v3, 2, v133
    v_and_b32 v2, 15, v0
    v_lshlrev_b32 v94, 9, v1
    v_lshl_add_u32 v94, v2, 4, v94
    v_and_b32 v135, 32, v0
    v_lshlrev_b32 v135, 12, v135
    v_and_b32 v124, 16, v0
    v_lshl_add_u32 v135, v124, 9, v135
    v_lshl_add_u32 v135, v2, 2, v135
    v_and_b32 v124, 1, v0
    v_lshlrev_b32 v124, 4, v124
    v_mov_b32 v125, 0xffff
    v_lshlrev_b32 v124, v124, v125
    v_bfe_u32 v125, v0, 1, 2
    v_cmp_eq_u32 vcc, 0, v125
    s_nop 1
    v_cndmask_b32 v88, 0, v124, vcc
    v_cmp_eq_u32 vcc, 1, v125
    s_nop 1
    v_cndmask_b32 v89, 0, v124, vcc
    v_cmp_eq_u32 vcc, 2, v125
    s_nop 1
    v_cndmask_b32 v90, 0, v124, vcc
    v_cmp_eq_u32 vcc, 3, v125
    s_nop 1
    v_cndmask_b32 v91, 0, v124, vcc
    v_bfe_u32 v124, v0, 3, 1
    v_lshlrev_b32 v124, 9, v124
    v_lshl_add_u32 v124, v1, 6, v124
    v_lshl_add_u32 v99, v3, 4, v124
    v_lshlrev_b32 v97, 3, v2
    v_and_b32 v98, 8, v0
    v_lshlrev_b32 v98, 3, v98
    s_lshl_b32 s56, s30, 3
    v_add_u32 v98, s56, v98
    v_lshrrev_b32 v137, 5, v0
    v_lshlrev_b32 v128, 10, v137
    v_lshl_add_u32 v128, v2, 5, v128
    v_and_b32 v124, 16, v0
    s_lshl_b32 s56, s30, 11
    v_add3_u32 v128, v128, v124, s56
    v_and_b32 v125, 7, v0
    v_lshlrev_b32 v137, 8, v137
    v_lshl_add_u32 v137, v125, 5, v137
    s_lshl_b32 s56, s30, 9
    v_add3_u32 v137, v137, v124, s56
    v_lshlrev_b32 v138, 10, v1
    v_lshl_add_u32 v138, v2, 4, v138
    s_and_b32 s59, s30, 1
    s_lshl_b32 s56, s59, 10
    v_lshl_add_u32 v129, v0, 4, s56
    v_lshrrev_b32 v130, 2, v0
    v_lshlrev_b32 v130, 11, v130
    v_lshl_add_u32 v130, v3, 4, v130
    v_bfe_u32 v139, v0, 3, 2
    v_lshrrev_b32 v124, 5, v0
    v_lshlrev_b32 v136, 7, v124
    v_lshl_add_u32 v136, v139, 4, v136
    v_mul_u32_u24 v124, 14336, v124
    v_lshl_add_u32 v125, v125, 4, v124
    v_lshrrev_b32 v131, 2, v0
    v_lshlrev_b32 v132, 6, v131
    v_lshl_add_u32 v132, v3, 4, v132
    v_lshlrev_b32 v131, 4, v131
    v_lshlrev_b32 v134, 6, v0
    v_and_b32 v96, 1, v0
    v_lshlrev_b32 v96, 4, v96
    v_sub_u32 v96, 16, v96
    s_lshl_b32 s64, s28, 16
    s_lshl_b32 s56, s59, 15
    s_add_u32 s64, s64, s56
    s_lshl_b32 s56, s29, 6
    s_add_u32 s64, s64, s56
    s_add_u32 s64, s64, 524288
    s_and_b32 s59, s30, 3
    s_lshl_b32 s59, s59, 11
    s_and_b32 s56, s30, 4
    s_lshl_b32 s56, s56, 11
    s_add_u32 s59, s59, s56
    s_lshl_b32 s65, s28, 16
    s_add_u32 s65, s65, s59
    s_add_u32 s65, s65, 524288
    s_lshl_b32 s56, s28, 12
    s_lshl_b32 s59, s30, 7
    s_add_u32 s56, s56, s59
    s_and_b32 s59, s56, 0x6000
    s_add_u32 s35, s56, s59
    s_add_u32 s35, s35, 1835008
    s_lshl_b32 s18, s28, 16
    s_add_u32 s18, s18, s56
    s_add_u32 s18, s18, 1310720
    s_lshl_b32 s66, s28, 10
    s_add_u32 s66, s66, 196608
    s_lshl_b32 s59, s29, 4
    s_add_u32 s34, s66, s59
    s_cmp_eq_u32 s30, 6
    s_cselect_b32 s34, s34, 2097152
    s_lshl_b32 s67, s28, 13
    s_add_u32 s67, s67, 262144
    s_lshl_b32 s52, s28, 16
    s_lshl_b32 s59, s30, 8
    s_add_u32 s52, s52, s59
    s_add_u32 s52, s52, 1310720
    s_and_b32 s14, s28, 1
    s_lshl_b32 s14, s14, 17
    s_add_u32 s14, s14, s59
    s_add_u32 s14, s14, 1835008
    s_mul_i32 s56, s30, 28672
    s_lshl_b32 s59, s28, 7
    s_add_u32 s56, s56, s59
    v_add_u32 v95, s56, v125
    s_movk_i32 s4, 896
    s_movk_i32 s5, 3584
    s_mov_b32 s51, 0x20000
    s_mov_b32 s50, 1605632
    s_and_b32 s59, s29, 7
    s_cmp_eq_u32 s59, 2
    s_cselect_b32 s3, 3, 2
    s_add_u32 s3, s3, 3212836864
    v_mov_b32 v109, 0
    s_waitcnt vmcnt(2)
    buffer_load_dwordx4 v[16:19], v93, s[40:43], s57 offen offset:256 nt
    s_waitcnt vmcnt(2)
    buffer_load_dwordx4 v[20:23], v93, s[40:43], s54 offen offset:0 nt
    s_waitcnt vmcnt(2)
    buffer_load_dwordx4 v[24:27], v93, s[40:43], s54 offen offset:256 nt
    s_waitcnt vmcnt(2)
    buffer_load_dwordx4 v[28:31], v93, s[40:43], s25 offen offset:0 nt
    s_waitcnt vmcnt(2)
    buffer_load_dwordx4 v[32:35], v93, s[40:43], s25 offen offset:256 nt
L_pk_1:
    ds_read_b32 v108, v109 offset:1152
    s_waitcnt lgkmcnt(0)
    v_cmp_le_i32 vcc, 0, v108
    s_getreg_b32 s53, hwreg(HW_REG_IB_STS, 0, 4)
    s_cbranch_vccnz L_site_8
    s_cmp_ge_u32 s53, 3
    s_cbranch_scc1 L_pk_1
    s_waitcnt vmcnt(2)
    buffer_load_dwordx4 v[36:39], v94, s[44:47], 0 offen offset:0 nt
L_pk_2:
    ds_read_b32 v108, v109 offset:1152
    s_waitcnt lgkmcnt(0)
    v_cmp_le_i32 vcc, 0, v108
    s_getreg_b32 s53, hwreg(HW_REG_IB_STS, 0, 4)
    s_cbranch_vccnz L_site_9
    s_cmp_ge_u32 s53, 3
    s_cbranch_scc1 L_pk_2
    s_waitcnt vmcnt(2)
    buffer_load_dwordx4 v[40:43], v94, s[44:47], 0 offen offset:256 nt
L_pk_3:
    ds_read_b32 v108, v109 offset:1152
    s_waitcnt lgkmcnt(0)
    v_cmp_le_i32 vcc, 0, v108
    s_getreg_b32 s53, hwreg(HW_REG_IB_STS, 0, 4)
    s_cbranch_vccnz L_site_10
    s_cmp_ge_u32 s53, 3
    s_cbranch_scc1 L_pk_3
    s_waitcnt vmcnt(2)
    buffer_load_dwordx4 v[44:47], v94, s[44:47], s57 offen offset:0 nt
L_pk_4:
    ds_read_b32 v108, v109 offset:1152
    s_waitcnt lgkmcnt(0)
    v_cmp_le_i32 vcc, 0, v108
    s_getreg_b32 s53, hwreg(HW_REG_IB_STS, 0, 4)
    s_cbranch_vccnz L_site_11
    s_cmp_ge_u32 s53, 3
    s_cbranch_scc1 L_pk_4
    s_waitcnt vmcnt(2)
    buffer_load_dwordx4 v[48:51], v94, s[44:47], s57 offen offset:256 nt
L_pk_5:
    ds_read_b32 v108, v109 offset:1152
    s_waitcnt lgkmcnt(0)
    v_cmp_le_i32 vcc, 0, v108
    s_getreg_b32 s53, hwreg(HW_REG_IB_STS, 0, 4)
    s_cbranch_vccnz L_site_12
    s_cmp_ge_u32 s53, 3
    s_cbranch_scc1 L_pk_5
    s_waitcnt vmcnt(2)
    buffer_load_dwordx4 v[52:55], v94, s[44:47], s54 offen offset:0 nt
L_pk_6:
    ds_read_b32 v108, v109 offset:1152
    s_waitcnt lgkmcnt(0)
    v_cmp_le_i32 vcc, 0, v108
    s_getreg_b32 s53, hwreg(HW_REG_IB_STS, 0, 4)
    s_cbranch_vccnz L_site_13
    s_cmp_ge_u32 s53, 3
    s_cbranch_scc1 L_pk_6
    s_waitcnt vmcnt(2)
    buffer_load_dwordx4 v[56:59], v94, s[44:47], s54 offen offset:256 nt
L_pk_7:
    ds_read_b32 v108, v109 offset:1152
    s_waitcnt lgkmcnt(0)
    v_cmp_le_i32 vcc, 0, v108
    s_getreg_b32 s53, hwreg(HW_REG_IB_STS, 0, 4)
    s_cbranch_vccnz L_site_14
    s_cmp_ge_u32 s53, 3
    s_cbranch_scc1 L_pk_7
    s_waitcnt vmcnt(2)
    buffer_load_dwordx4 v[60:63], v94, s[44:47], s25 offen offset:0 nt
L_pk_8:
    ds_read_b32 v108, v109 offset:1152
    s_waitcnt lgkmcnt(0)
    v_cmp_le_i32 vcc, 0, v108
    s_getreg_b32 s53, hwreg(HW_REG_IB_STS, 0, 4)
    s_cbranch_vccnz L_site_15
    s_cmp_ge_u32 s53, 3
    s_cbranch_scc1 L_pk_8
    s_waitcnt vmcnt(2)
    buffer_load_dwordx4 v[64:67], v94, s[44:47], s25 offen offset:256 nt
    s_mov_b32 s62, 0
L_qspin:
    ds_read_b32 v108, v109 offset:1152
    s_waitcnt lgkmcnt(0)
    v_cmp_le_i32 vcc, 0, v108
    s_cbranch_vccnz L_site_16
    s_sleep 1
    s_add_u32 s62, s62, 1
    s_cmp_lt_u32 s62, 8388608
    s_cbranch_scc1 L_qspin
    s_branch L_site_16
L_site_8:
    buffer_load_dwordx4 v[36:39], v94, s[44:47], 0 offen offset:0 nt
L_site_9:
    buffer_load_dwordx4 v[40:43], v94, s[44:47], 0 offen offset:256 nt
L_site_10:
    buffer_load_dwordx4 v[44:47], v94, s[44:47], s57 offen offset:0 nt
    buffer_load_dwordx4 v[48:51], v94, s[44:47], s57 offen offset:256 nt
    s_mov_b32 s15, 12
    s_waitcnt vmcnt(4)
    s_branch L_qk
L_site_11:
    buffer_load_dwordx4 v[48:51], v94, s[44:47], s57 offen offset:256 nt
    buffer_load_dwordx4 v[52:55], v94, s[44:47], s54 offen offset:0 nt
    buffer_load_dwordx4 v[56:59], v94, s[44:47], s54 offen offset:256 nt
    s_mov_b32 s15, 14
    s_branch L_qk
L_site_12:
    buffer_load_dwordx4 v[52:55], v94, s[44:47], s54 offen offset:0 nt
    buffer_load_dwordx4 v[56:59], v94, s[44:47], s54 offen offset:256 nt
    buffer_load_dwordx4 v[60:63], v94, s[44:47], s25 offen offset:0 nt
    s_mov_b32 s15, 15
    s_branch L_qk
L_site_13:
    buffer_load_dwordx4 v[56:59], v94, s[44:47], s54 offen offset:256 nt
    buffer_load_dwordx4 v[60:63], v94, s[44:47], s25 offen offset:0 nt
    buffer_load_dwordx4 v[64:67], v94, s[44:47], s25 offen offset:256 nt
    s_mov_b32 s15, 16
    s_branch L_qk
L_site_14:
    buffer_load_dwordx4 v[60:63], v94, s[44:47], s25 offen offset:0 nt
    buffer_load_dwordx4 v[64:67], v94, s[44:47], s25 offen offset:256 nt
    s_mov_b32 s15, 16
    s_branch L_qk
L_site_15:
    buffer_load_dwordx4 v[64:67], v94, s[44:47], s25 offen offset:256 nt
    s_mov_b32 s15, 16
    s_branch L_qk
L_site_16:
    s_mov_b32 s15, 16
L_qk:
    ds_read_b128 v[100:103], v99 offset:0
    ds_read_b128 v[104:107], v99 offset:256
    v_readfirstlane_b32 s63, v108
    ds_read_b32 v92, v109 offset:1156
    s_waitcnt lgkmcnt(0)
    v_and_b32 v92, 1023, v92
    s_nop 0
    v_readfirstlane_b32 s31, v92
    v_mfma_f32_16x16x32_bf16 v[108:111], v[4:7], v[100:103], 0
    v_mfma_f32_16x16x32_bf16 v[112:115], v[12:15], v[100:103], 0
    v_mfma_f32_16x16x32_bf16 v[116:119], v[20:23], v[100:103], 0
    v_mfma_f32_16x16x32_bf16 v[120:123], v[28:31], v[100:103], 0
    v_mfma_f32_16x16x32_bf16 v[108:111], v[8:11], v[104:107], v[108:111]
    v_mfma_f32_16x16x32_bf16 v[112:115], v[16:19], v[104:107], v[112:115]
    v_mfma_f32_16x16x32_bf16 v[116:119], v[24:27], v[104:107], v[116:119]
    v_mfma_f32_16x16x32_bf16 v[120:123], v[32:35], v[104:107], v[120:123]
    s_nop 4
    v_mov_b32_dpp v100, v108 quad_perm:[0,0,0,0] row_mask:0xf bank_mask:0xf
    v_mov_b32_dpp v101, v112 quad_perm:[0,0,0,0] row_mask:0xf bank_mask:0xf
    v_mov_b32_dpp v102, v116 quad_perm:[0,0,0,0] row_mask:0xf bank_mask:0xf
    v_mov_b32_dpp v103, v120 quad_perm:[0,0,0,0] row_mask:0xf bank_mask:0xf
    v_add_f32_dpp v100, v109, v100 quad_perm:[1,1,1,1] row_mask:0xf bank_mask:0xf
    v_add_f32_dpp v101, v113, v101 quad_perm:[1,1,1,1] row_mask:0xf bank_mask:0xf
    v_add_f32_dpp v102, v117, v102 quad_perm:[1,1,1,1] row_mask:0xf bank_mask:0xf
    v_add_f32_dpp v103, v121, v103 quad_perm:[1,1,1,1] row_mask:0xf bank_mask:0xf
    v_add_f32_dpp v100, v110, v100 quad_perm:[2,2,2,2] row_mask:0xf bank_mask:0xf
    v_add_f32_dpp v101, v114, v101 quad_perm:[2,2,2,2] row_mask:0xf bank_mask:0xf
    v_add_f32_dpp v102, v118, v102 quad_perm:[2,2,2,2] row_mask:0xf bank_mask:0xf
    v_add_f32_dpp v103, v122, v103 quad_perm:[2,2,2,2] row_mask:0xf bank_mask:0xf
    v_add_f32_dpp v100, v111, v100 quad_perm:[3,3,3,3] row_mask:0xf bank_mask:0xf
    v_add_f32_dpp v101, v115, v101 quad_perm:[3,3,3,3] row_mask:0xf bank_mask:0xf
    v_add_f32_dpp v102, v119, v102 quad_perm:[3,3,3,3] row_mask:0xf bank_mask:0xf
    v_add_f32_dpp v103, v123, v103 quad_perm:[3,3,3,3] row_mask:0xf bank_mask:0xf
    v_cvt_pk_bf16_f32 v124, v100, v101
    v_cvt_pk_bf16_f32 v125, v102, v103
    v_lshlrev_b32 v100, 16, v124
    v_and_b32 v101, 0xffff0000, v124
    v_lshlrev_b32 v102, 16, v125
    v_and_b32 v103, 0xffff0000, v125
    v_max3_f32 v126, v100, v101, v102
    v_max_f32 v126, v126, v103
    v_mov_b32 v124, v126
    s_nop 1
    v_permlane16_swap_b32 v126, v124
    v_max_f32 v126, v126, v124
    v_mov_b32 v124, v126
    s_nop 1
    v_permlane32_swap_b32 v126, v124
    v_max_f32 v126, v126, v124
    v_sub_f32 v100, v100, v126
    v_sub_f32 v101, v101, v126
    v_sub_f32 v102, v102, v126
    v_sub_f32 v103, v103, v126
    v_mul_f32 v100, s61, v100
    v_mul_f32 v101, s61, v101
    v_mul_f32 v102, s61, v102
    v_mul_f32 v103, s61, v103
    v_exp_f32 v100, v100
    v_exp_f32 v101, v101
    v_exp_f32 v102, v102
    v_exp_f32 v103, v103
    v_add_f32 v127, v100, v101
    v_add_f32 v124, v102, v103
    v_add_f32 v127, v127, v124
    v_mov_b32 v124, v127
    s_nop 1
    v_permlane16_swap_b32 v127, v124
    v_add_f32 v127, v127, v124
    v_mov_b32 v124, v127
    s_nop 1
    v_permlane32_swap_b32 v127, v124
    v_add_f32 v127, v127, v124
    s_mov_b64 exec, 0x101
    ds_write_b64 v98, v[126:127] offset:1024
    s_mov_b64 exec, -1
    s_cmp_gt_u32 s15, 12
    s_cbranch_scc1 L_sk_9
    buffer_load_dwordx4 v[52:55], v94, s[44:47], s54 offen offset:0 nt
L_sk_9:
    s_cmp_gt_u32 s15, 13
    s_cbranch_scc1 L_sk_10
    buffer_load_dwordx4 v[56:59], v94, s[44:47], s54 offen offset:256 nt
L_sk_10:
    s_cmp_gt_u32 s15, 14
    s_cbranch_scc1 L_sk_11
    buffer_load_dwordx4 v[60:63], v94, s[44:47], s25 offen offset:0 nt
L_sk_11:
    s_cmp_gt_u32 s15, 15
    s_cbranch_scc1 L_sk_12
    buffer_load_dwordx4 v[64:67], v94, s[44:47], s25 offen offset:256 nt
L_sk_12:
    s_mov_b32 s62, 0
L_mspin:
    ds_read_b64 v[108:109], v97 offset:1024
    s_add_u32 s62, s62, 1
    s_cmp_ge_u32 s62, 8388608
    s_waitcnt lgkmcnt(0)
    v_cmp_gt_f32 vcc, 0, v109
    s_cbranch_scc1 L_mdone
    s_cbranch_vccnz L_mspin
L_mdone:
    v_max_f32_dpp v112, v108, v108 quad_perm:[1,0,3,2] row_mask:0xf bank_mask:0xf
    s_nop 1
    v_max_f32_dpp v112, v112, v112 quad_perm:[2,3,0,1] row_mask:0xf bank_mask:0xf
    s_nop 1
    v_max_f32_dpp v112, v112, v112 row_half_mirror row_mask:0xf bank_mask:0xf
    v_sub_f32 v124, v126, v112
    v_mul_f32 v124, s61, v124
    v_exp_f32 v124, v124
    s_nop 0
    v_mul_f32 v100, v100, v124
    v_mul_f32 v101, v101, v124
    v_mul_f32 v102, v102, v124
    v_mul_f32 v103, v103, v124
    v_cvt_pk_bf16_f32 v100, v100, v100
    v_cvt_pk_bf16_f32 v101, v101, v101
    v_cvt_pk_bf16_f32 v102, v102, v102
    v_cvt_pk_bf16_f32 v103, v103, v103
    v_and_b32 v4, v100, v88
    v_and_b32 v5, v100, v89
    v_and_b32 v6, v100, v90
    v_and_b32 v7, v100, v91
    v_and_b32 v8, v101, v88
    v_and_b32 v9, v101, v89
    v_and_b32 v10, v101, v90
    v_and_b32 v11, v101, v91
    v_and_b32 v12, v102, v88
    v_and_b32 v13, v102, v89
    v_and_b32 v14, v102, v90
    v_and_b32 v15, v102, v91
    v_and_b32 v16, v103, v88
    v_and_b32 v17, v103, v89
    v_and_b32 v18, v103, v90
    v_and_b32 v19, v103, v91
    s_setprio 2
    v_mov_b32 v126, 1
    v_mov_b32 v127, 0
    s_waitcnt vmcnt(7)
    v_mfma_f32_16x16x32_bf16 v[116:119], v[4:7], v[36:39], 0
    s_waitcnt vmcnt(6)
    v_mfma_f32_16x16x32_bf16 v[120:123], v[4:7], v[40:43], 0
    s_waitcnt vmcnt(5)
    v_mfma_f32_16x16x32_bf16 v[116:119], v[8:11], v[44:47], v[116:119]
    s_waitcnt vmcnt(4)
    v_mfma_f32_16x16x32_bf16 v[120:123], v[8:11], v[48:51], v[120:123]
    s_waitcnt vmcnt(3)
    v_mfma_f32_16x16x32_bf16 v[116:119], v[12:15], v[52:55], v[116:119]
    s_waitcnt vmcnt(2)
    v_mfma_f32_16x16x32_bf16 v[120:123], v[12:15], v[56:59], v[120:123]
    s_waitcnt vmcnt(1)
    v_mfma_f32_16x16x32_bf16 v[116:119], v[16:19], v[60:63], v[116:119]
    s_waitcnt vmcnt(0)
    v_mfma_f32_16x16x32_bf16 v[120:123], v[16:19], v[64:67], v[120:123]
    s_nop 5
    ds_write_b128 v128, v[116:119] offset:2048
    s_nop 0
    ds_write_b128 v128, v[120:123] offset:2560
    s_mov_b64 exec, 1
    ds_add_u32 v127, v126 offset:1160
    s_mov_b64 exec, -1
    s_and_b32 s53, s30, 6
    s_cmp_eq_u32 s53, 4
    s_cbranch_scc0 L_wr_14
    s_mov_b32 s62, 0
L_lw_15:
    ds_read_b32 v124, v127 offset:1160
    s_add_u32 s62, s62, 1
    s_cmp_ge_u32 s62, 8388608
    s_waitcnt lgkmcnt(0)
    v_cmp_gt_u32 vcc, 0xbf800008, v124
    s_cbranch_scc1 L_lwok_16
    s_cbranch_vccnz L_lw_15
L_lwok_16:
L_comb:
    ds_read_b128 v[36:39], v129 offset:2048
    ds_read_b128 v[40:43], v129 offset:4096
    ds_read_b128 v[44:47], v129 offset:6144
    ds_read_b128 v[48:51], v129 offset:8192
    ds_read_b128 v[52:55], v129 offset:10240
    ds_read_b128 v[56:59], v129 offset:12288
    ds_read_b128 v[60:63], v129 offset:14336
    ds_read_b128 v[64:67], v129 offset:16384
    s_cmp_eq_u32 s63, 1
    s_waitcnt lgkmcnt(6)
    v_pk_add_f32 v[36:37], v[36:37], v[40:41]
    v_pk_add_f32 v[38:39], v[38:39], v[42:43]
    s_waitcnt lgkmcnt(4)
    v_pk_add_f32 v[44:45], v[44:45], v[48:49]
    v_pk_add_f32 v[46:47], v[46:47], v[50:51]
    v_pk_add_f32 v[36:37], v[36:37], v[44:45]
    v_pk_add_f32 v[38:39], v[38:39], v[46:47]
    s_waitcnt lgkmcnt(2)
    v_pk_add_f32 v[52:53], v[52:53], v[56:57]
    v_pk_add_f32 v[54:55], v[54:55], v[58:59]
    s_waitcnt lgkmcnt(0)
    v_pk_add_f32 v[60:61], v[60:61], v[64:65]
    v_pk_add_f32 v[62:63], v[62:63], v[66:67]
    v_pk_add_f32 v[52:53], v[52:53], v[60:61]
    v_pk_add_f32 v[54:55], v[54:55], v[62:63]
    v_pk_add_f32 v[36:37], v[36:37], v[52:53]
    v_pk_add_f32 v[38:39], v[38:39], v[54:55]
    v_and_or_b32 v36, v36, s60, v92
    v_and_or_b32 v37, v37, s60, v92
    v_and_or_b32 v38, v38, s60, v92
    v_and_or_b32 v39, v39, s60, v92
    s_cbranch_scc0 L_ps_17
    buffer_store_dwordx4 v[36:39], v130, s[36:39], s64 offen
L_pj_18:
    s_mov_b64 exec, 1
    ds_add_u32 v127, v126 offset:1164
    s_mov_b64 exec, -1
L_wr_14:
    s_setprio 0
    s_mov_b32 s62, 0
L_rt_19:
    ds_read_b32 v124, v127 offset:1168
    s_add_u32 s62, s62, 1
    s_waitcnt lgkmcnt(0)
    v_readfirstlane_b32 s55, v124
    s_cmp_ge_u32 s62, 8388608
    s_cbranch_scc1 L_exit
    s_cmp_lt_i32 s55, 0
    s_cbranch_scc1 L_rt_19
    s_cmp_ge_u32 s55, 24
    s_cbranch_scc1 L_ga_13
    s_cmp_eq_u32 s28, 7
    s_cbranch_scc1 L_exit
    s_cmp_eq_u32 s55, 23
    s_cbranch_scc1 L_exit
    s_lshl_b32 s53, s55, 11
    s_add_u32 s52, s52, s53
    s_and_b32 s56, s53, 0xe000
    s_add_u32 s53, s53, s56
    s_add_u32 s14, s14, s53
    s_lshl_b32 s53, s55, 6
    s_add_u32 s67, s67, s53
    s_lshr_b32 s53, s55, 1
    s_and_b32 s56, s55, 15
    s_cmp_lt_u32 s55, 16
    s_cselect_b32 s48, s12, s20
    s_cselect_b32 s49, s13, s21
    s_cselect_b32 s50, 3670016, s50
    s_cselect_b32 s53, s53, s56
    s_cselect_b32 s4, 3584, s4
    s_cselect_b32 s55, 896, s5
    s_cmp_eq_u32 s53, s28
    s_cselect_b32 s52, s52, s14
    s_cselect_b32 s14, 0, 0x2000
    s_mul_i32 s53, s56, 229376
    v_mad_u32_u24 v95, v139, s55, v95
    s_lshl_b32 s5, s4, 1
    s_add_u32 s6, s5, s4
    v_add_u32 v95, s53, v95
L_dec_done:
    ds_read_b32 v97, v127 offset:1176
    s_mov_b32 s62, 0
L_lw_20:
    ds_read_b32 v124, v127 offset:1164
    s_add_u32 s62, s62, 1
    s_cmp_ge_u32 s62, 8388608
    s_waitcnt lgkmcnt(0)
    v_cmp_gt_u32 vcc, s3, v124
    s_cbranch_scc1 L_lwok_21
    s_cbranch_vccnz L_lw_20
L_lwok_21:
    v_and_b32 v98, s14, v97
    v_add_u32 v136, v136, v98
    buffer_load_dwordx4 v[84:87], v136, s[36:39], s52 offen sc1
L_x1_23:
    buffer_load_dwordx4 v[68:71], v95, s[48:51], 0 offen nt
    buffer_load_dwordx4 v[72:75], v95, s[48:51], s4 offen nt
    buffer_load_dwordx4 v[76:79], v95, s[48:51], s5 offen nt
    buffer_load_dwordx4 v[80:83], v95, s[48:51], s6 offen nt
    s_waitcnt vmcnt(4)
    v_bitop3_b32 v124, v84, v85, s31 bitop3:0x7e
    v_bitop3_b32 v125, v86, v87, s31 bitop3:0x7e
    v_lshrrev_b32 v100, v96, v84
    v_lshrrev_b32 v101, v96, v85
    v_lshrrev_b32 v102, v96, v86
    v_lshrrev_b32 v103, v96, v87
    v_or_b32 v124, v124, v125
    v_and_b32 v124, 0xffff, v124
    v_cmp_ne_u32 vcc, 0, v124
    s_cbranch_vccz L_xo_22
L_x2_24:
    s_waitcnt vmcnt(3)
    ds_read_b32 v97, v127 offset:1176
    s_waitcnt vmcnt(3) lgkmcnt(0)
    v_and_b32 v97, s14, v97
    v_sub_u32 v97, v97, v98
    v_add_u32 v136, v136, v97
    s_mov_b32 s62, 0
    s_branch L_x_top_25
L_x_retry_26:
    s_add_u32 s62, s62, 1
    s_cmp_ge_u32 s62, 1048576
    s_cbranch_scc1 L_x_ok_27
L_x_top_25:
    buffer_load_dwordx4 v[84:87], v136, s[36:39], s52 offen sc1
    s_waitcnt vmcnt(0)
    v_bitop3_b32 v124, v84, v85, s31 bitop3:0x7e
    v_bitop3_b32 v125, v86, v87, s31 bitop3:0x7e
    v_lshrrev_b32 v100, v96, v84
    v_lshrrev_b32 v101, v96, v85
    v_lshrrev_b32 v102, v96, v86
    v_lshrrev_b32 v103, v96, v87
    v_or_b32 v124, v124, v125
    v_and_b32 v124, 0xffff, v124
    v_cmp_ne_u32 vcc, 0, v124
    s_cbranch_vccnz L_x_retry_26
L_x_ok_27:
L_xo_22:
    s_setprio 2
    v_and_b32 v4, v100, v88
    v_and_b32 v5, v100, v89
    v_and_b32 v6, v100, v90
    v_and_b32 v7, v100, v91
    v_and_b32 v8, v101, v88
    v_and_b32 v9, v101, v89
    v_and_b32 v10, v101, v90
    v_and_b32 v11, v101, v91
    s_waitcnt vmcnt(3)
    v_mfma_f32_16x16x32_bf16 v[108:111], v[4:7], v[68:71], 0
    v_and_b32 v12, v102, v88
    v_and_b32 v13, v102, v89
    v_and_b32 v14, v102, v90
    v_and_b32 v15, v102, v91
    s_waitcnt vmcnt(2)
    v_mfma_f32_16x16x32_bf16 v[108:111], v[8:11], v[72:75], v[108:111]
    v_and_b32 v16, v103, v88
    v_and_b32 v17, v103, v89
    v_and_b32 v18, v103, v90
    v_and_b32 v19, v103, v91
    s_waitcnt vmcnt(1)
    v_mfma_f32_16x16x32_bf16 v[108:111], v[12:15], v[76:79], v[108:111]
    s_waitcnt vmcnt(0)
    v_mfma_f32_16x16x32_bf16 v[108:111], v[16:19], v[80:83], v[108:111]
    s_mov_b32 exec_lo, 0x00ff00ff
    s_mov_b32 exec_hi, 0xff00ff00
    s_nop 5
    ds_write_b128 v137, v[108:111] offset:18432
    s_mov_b64 exec, 1
    ds_add_rtn_u32 v126, v127, v126 offset:1172
    s_mov_b64 exec, -1
    s_waitcnt lgkmcnt(0)
    v_readfirstlane_b32 s53, v126
    s_cmp_eq_u32 s53, 3212836871
    s_cbranch_scc0 L_exit
    ds_read_b128 v[36:39], v138 offset:18432
    ds_read_b128 v[40:43], v138 offset:18688
    ds_read_b128 v[44:47], v138 offset:18944
    ds_read_b128 v[48:51], v138 offset:19200
    s_cmp_eq_u32 s63, 1
    s_waitcnt lgkmcnt(2)
    v_pk_add_f32 v[36:37], v[36:37], v[40:41]
    v_pk_add_f32 v[38:39], v[38:39], v[42:43]
    s_waitcnt lgkmcnt(0)
    v_pk_add_f32 v[44:45], v[44:45], v[48:49]
    v_pk_add_f32 v[46:47], v[46:47], v[50:51]
    v_pk_add_f32 v[36:37], v[36:37], v[44:45]
    v_pk_add_f32 v[38:39], v[38:39], v[46:47]
    s_nop 1
    v_permlane32_swap_b32 v36, v38
    v_permlane32_swap_b32 v37, v39
    v_add_f32 v36, v36, v38
    v_add_f32 v37, v37, v39
    s_nop 1
    v_permlane16_swap_b32 v36, v37
    v_add_f32 v36, v36, v37
    v_and_or_b32 v36, v36, s60, v92
    s_cbranch_scc0 L_ps_29
    buffer_store_dword v36, v133, s[36:39], s67 offen
L_pj_30:
    s_endpgm
L_ga_13:
    s_cmp_ge_u32 s30, 4
    s_cbranch_scc1 L_exit
    s_and_b32 s55, s55, 7
    s_and_b32 s53, s55, 4
    s_lshl_b32 s53, s53, 7
    s_add_u32 s66, s66, s53
    s_lshl_b32 s53, s55, 13
    s_add_u32 s65, s65, s53
    s_add_u32 s3, s65, 1024
    buffer_load_dwordx4 v[4:7], v132, s[36:39], s65 offen sc1
    buffer_load_dwordx4 v[8:11], v132, s[36:39], s3 offen sc1
    s_and_b32 s53, s55, 4
    s_lshl_b32 s53, s53, 5
    s_add_u32 s53, s53, 1280
    v_lshrrev_b32 v131, 2, v131
    v_add_u32 v131, s53, v131
    s_lshl_b32 s53, s55, 9
    s_add_u32 s35, s35, s53
    s_add_u32 s18, s18, s53
    s_mov_b32 s53, 0xffff0000
    s_mov_b32 s62, 0
    s_branch L_o_chk_34
L_o_retry_32:
    s_add_u32 s62, s62, 1
    s_cmp_ge_u32 s62, 1048576
    s_cbranch_scc1 L_o_ok_33
L_o_top_31:
    buffer_load_dwordx4 v[4:7], v132, s[36:39], s65 offen sc1
    buffer_load_dwordx4 v[8:11], v132, s[36:39], s3 offen sc1
L_o_chk_34:
    s_waitcnt vmcnt(0)
    ds_read2_b32 v[12:13], v131 offset1:16
    v_xor_b32 v4, s31, v4
    v_xor_b32 v5, s31, v5
    v_xor_b32 v6, s31, v6
    v_xor_b32 v7, s31, v7
    v_or3_b32 v126, v4, v5, v6
    v_or_b32 v126, v126, v7
    v_xor_b32 v8, s31, v8
    v_xor_b32 v9, s31, v9
    v_xor_b32 v10, s31, v10
    v_xor_b32 v11, s31, v11
    v_or3_b32 v126, v126, v8, v9
    v_or3_b32 v126, v126, v10, v11
    v_and_b32 v126, 1023, v126
    v_cmp_ne_u32 vcc, 0, v126
    s_cbranch_vccnz L_o_retry_32
L_o_ok_33:
L_ww_35:
    s_waitcnt lgkmcnt(0)
    v_cmp_gt_f32 vcc, 0, v12
    s_cbranch_vccz L_wk_36
    ds_read2_b32 v[12:13], v131 offset1:16
    s_add_u32 s62, s62, 1
    s_cmp_lt_u32 s62, 8388608
    s_cbranch_scc1 L_ww_35
    s_waitcnt lgkmcnt(0)
L_wk_36:
    v_mul_f32 v4, v4, v12
    v_mul_f32 v5, v5, v12
    v_mul_f32 v6, v6, v12
    v_mul_f32 v7, v7, v12
    v_fmac_f32 v4, v8, v13
    v_fmac_f32 v5, v9, v13
    v_fmac_f32 v6, v10, v13
    v_fmac_f32 v7, v11, v13
    s_cmp_eq_u32 s63, 1
    v_add_f32_dpp v8, v4, v4 row_ror:8 row_mask:0xf bank_mask:0x3
    v_add_f32_dpp v9, v5, v5 row_ror:8 row_mask:0xf bank_mask:0x3
    s_nop 0
    v_add_f32_dpp v8, v6, v6 row_ror:8 row_mask:0xf bank_mask:0xc
    v_add_f32_dpp v9, v7, v7 row_ror:8 row_mask:0xf bank_mask:0xc
    s_nop 0
    v_add_f32_dpp v4, v8, v8 row_shl:4 row_mask:0xf bank_mask:0x5
    s_nop 1
    v_add_f32_dpp v4, v9, v9 row_shr:4 row_mask:0xf bank_mask:0xa
    v_mov_b32 v124, v4
    s_nop 1
    v_permlane16_swap_b32 v4, v124
    v_add_f32 v4, v4, v124
    v_mov_b32 v124, v4
    s_nop 1
    v_permlane32_swap_b32 v4, v124
    v_add_f32 v4, v4, v124
    v_cvt_pk_bf16_f32 v4, v4, v4
    v_and_or_b32 v4, v4, s53, v92
    buffer_store_dword v4, v135, s[36:39], s35 offen sc1
    s_mov_b64 exec, 0xffff
    s_cbranch_scc0 L_ps_37
    buffer_store_dword v4, v135, s[36:39], s18 offen
L_pj_38:
    s_endpgm
    .p2align 8
L_h0b:
L_zr_39:
    s_lshl_b32 s58, s28, 7
    s_add_u32 s58, s58, 4096
    v_and_b32 v137, 32, v0
    v_mad_u32_u24 v137, v137, 15, v0
    v_lshl_add_u32 v137, v137, 2, s58
    v_mov_b32 v136, 0
    global_store_dword v137, v136, s[26:27] sc1
    s_branch L_zj_40
L_h0i:
    s_setprio 3
    s_and_b32 s53, s29, 3
    s_lshl_b32 s54, s28, 10
    s_and_b32 s59, s29, 28
    s_lshl_b32 s59, s59, 5
    s_add_u32 s54, s54, s59
    s_mul_i32 s59, s53, 917504
    s_add_u32 s54, s54, s59
    v_lshlrev_b32 v2, 4, v0
    v_lshrrev_b32 v1, 3, v0
    v_mul_u32_u24 v3, 28, v1
    v_mul_u32_u24 v132, 114688, v1
    v_and_b32 v133, 0x70, v2
    v_add_u32 v132, v133, v132
    s_mov_b32 s46, 909440
    s_mov_b32 s47, 0x20000
    s_movk_i32 s42, 896
    s_mov_b32 s43, s47
    s_mul_i32 s59, s53, 224
    s_movk_i32 s52, 8192
    s_movk_i32 s56, 8192
    s_waitcnt lgkmcnt(0)
    s_cmp_eq_u32 s29, 0
    s_cbranch_scc1 L_zr_39
L_zj_40:
    s_mov_b32 s40, s4
    s_mov_b32 s41, s5
    buffer_load_dwordx4 v[4:7], v2, s[40:43], 0 offen
    buffer_load_dwordx4 v[8:11], v3, s[40:43], s59 offen
    buffer_load_dwordx3 v[12:14], v3, s[40:43], s59 offen offset:16
    s_add_u32 s44, s10, s54
    s_addc_u32 s45, s11, 0
    buffer_load_dwordx4 v[16:19], v132, s[44:47], 0 offen nt
    buffer_load_dwordx4 v[20:23], v132, s[44:47], s56 offen nt
    s_add_u32 s56, s56, s52
    buffer_load_dwordx4 v[24:27], v132, s[44:47], s56 offen nt
    s_add_u32 s56, s56, s52
    buffer_load_dwordx4 v[28:31], v132, s[44:47], s56 offen nt
    s_add_u32 s56, s56, s52
.p2align 8
L_pad1:
    s_cbranch_execz L_h1m
    buffer_load_dwordx4 v[32:35], v132, s[44:47], s56 offen nt
    s_add_u32 s56, s56, s52
    buffer_load_dwordx4 v[36:39], v132, s[44:47], s56 offen nt
    s_add_u32 s56, s56, s52
    buffer_load_dwordx4 v[40:43], v132, s[44:47], s56 offen nt
    s_add_u32 s56, s56, s52
    buffer_load_dwordx4 v[44:47], v132, s[44:47], s56 offen nt
    s_add_u32 s56, s56, s52
    buffer_load_dwordx4 v[48:51], v132, s[44:47], s56 offen nt
    s_add_u32 s56, s56, s52
    buffer_load_dwordx4 v[52:55], v132, s[44:47], s56 offen nt
    s_add_u32 s56, s56, s52
    buffer_load_dwordx4 v[56:59], v132, s[44:47], s56 offen nt
    s_add_u32 s56, s56, s52
    buffer_load_dwordx4 v[60:63], v132, s[44:47], s56 offen nt
    s_add_u32 s56, s56, s52
    buffer_load_dwordx4 v[64:67], v132, s[44:47], s56 offen nt
    s_add_u32 s56, s56, s52
    buffer_load_dwordx4 v[68:71], v132, s[44:47], s56 offen nt
    v_mov_b32 v136, -1.0
    v_lshlrev_b32 v137, 2, v0
    ds_write_b32 v137, v136 offset:1024
    ds_write_b32 v137, v136 offset:1280
L_h0:
    v_mul_u32_u24 v132, 50176, v1
    v_add_u32 v132, v133, v132
    s_bitcmp1_b32 s29, 2
    s_cselect_b32 s44, s18, s16
    s_cselect_b32 s45, s19, s17
    s_lshr_b32 s58, s29, 3
    s_lshl_b32 s54, s28, 2
    s_add_u32 s54, s54, s58
    s_lshl_b32 s54, s54, 7
    s_mul_i32 s59, s53, 401408
    s_add_u32 s54, s54, s59
    s_add_u32 s44, s44, s54
    s_addc_u32 s45, s45, 0
    s_cmp_lt_u32 s28, 7
    s_cselect_b32 s46, 397952, 0
    s_movk_i32 s52, 3584
    s_movk_i32 s56, 3584
    s_setprio 0
    s_movk_i32 s56, 3584
    buffer_load_dwordx4 v[72:75], v132, s[44:47], 0 offen nt
    buffer_load_dwordx4 v[76:79], v132, s[44:47], s56 offen nt
    s_add_u32 s56, s56, s52
    buffer_load_dwordx4 v[80:83], v132, s[44:47], s56 offen nt
    s_add_u32 s56, s56, s52
    buffer_load_dwordx4 v[84:87], v132, s[44:47], s56 offen nt
    s_add_u32 s56, s56, s52
    buffer_load_dwordx4 v[88:91], v132, s[44:47], s56 offen nt
    s_add_u32 s56, s56, s52
    buffer_load_dwordx4 v[92:95], v132, s[44:47], s56 offen nt
    s_add_u32 s56, s56, s52
    buffer_load_dwordx4 v[96:99], v132, s[44:47], s56 offen nt
    s_add_u32 s56, s56, s52
    buffer_load_dwordx4 v[100:103], v132, s[44:47], s56 offen nt
    s_add_u32 s56, s56, s52
    buffer_load_dwordx4 v[104:107], v132, s[44:47], s56 offen nt
    s_add_u32 s56, s56, s52
    buffer_load_dwordx4 v[108:111], v132, s[44:47], s56 offen nt
    s_add_u32 s56, s56, s52
    buffer_load_dwordx4 v[112:115], v132, s[44:47], s56 offen nt
    s_add_u32 s56, s56, s52
    buffer_load_dwordx4 v[116:119], v132, s[44:47], s56 offen nt
    s_add_u32 s56, s56, s52
    buffer_load_dwordx4 v[120:123], v132, s[44:47], s56 offen nt
    s_add_u32 s56, s56, s52
    buffer_load_dwordx4 v[124:127], v132, s[44:47], s56 offen nt
    s_setprio 3
    s_waitcnt lgkmcnt(0)
    s_barrier
    s_mov_b32 s15, 0
    s_load_dword s32, s[26:27], 0
    s_mov_b32 s36, s26
    s_mov_b32 s37, s27
    s_mov_b32 s38, 2097152
    s_mov_b32 s39, 0x20000
    s_mov_b32 s60, 4294966272
    v_and_b32 v136, 1, v0
    v_lshlrev_b32 v136, 4, v136
    v_mov_b32 v137, 0xffff
    v_lshlrev_b32 v136, v136, v137
    v_bfe_u32 v137, v0, 1, 2
    v_cmp_eq_u32 vcc, 0, v137
    s_nop 1
    v_cndmask_b32 v128, 0, v136, vcc
    v_cmp_eq_u32 vcc, 1, v137
    s_nop 1
    v_cndmask_b32 v129, 0, v136, vcc
    v_cmp_eq_u32 vcc, 2, v137
    s_nop 1
    v_cndmask_b32 v130, 0, v136, vcc
    v_cmp_eq_u32 vcc, 3, v137
    s_nop 1
    v_cndmask_b32 v131, 0, v136, vcc
    v_and_b32 v3, 16, v0
    v_lshl_add_u32 v133, v133, 1, v3
    s_lshl_b32 s64, s28, 14
    s_add_u32 s64, s64, 1048576
    s_lshl_b32 s59, s53, 11
    s_add_u32 s55, s64, s59
    s_and_b32 s59, s29, 28
    s_lshl_b32 s59, s59, 6
    s_add_u32 s55, s55, s59
    s_and_b32 s59, s29, 7
    s_lshl_b32 s65, s59, 10
    s_and_b32 s59, s29, 24
    s_lshl_b32 s59, s59, 5
    s_add_u32 s65, s65, s59
    s_add_u32 s65, s65, s64
    s_add_u32 s65, s65, 8192
    s_getreg_b32 s3, hwreg(HW_REG_XCC_ID, 0, 3)
    s_lshl_b32 s3, s3, 4
    s_waitcnt vmcnt(30)
    v_lshlrev_b32 v138, 16, v4
    v_and_b32 v139, 0xffff0000, v4
    v_lshlrev_b32 v140, 16, v5
    v_and_b32 v141, 0xffff0000, v5
    v_lshlrev_b32 v142, 16, v6
    v_and_b32 v143, 0xffff0000, v6
    v_lshlrev_b32 v144, 16, v7
    v_and_b32 v145, 0xffff0000, v7
    v_readfirstlane_b32 s57, v138
    v_cmp_gt_u32 vcc, 56, v0
    s_nop 0
    v_subrev_f32 v138, s57, v138
    v_subrev_f32 v139, s57, v139
    v_subrev_f32 v140, s57, v140
    v_subrev_f32 v141, s57, v141
    v_subrev_f32 v142, s57, v142
    v_subrev_f32 v143, s57, v143
    v_subrev_f32 v144, s57, v144
    v_subrev_f32 v145, s57, v145
    v_add_f32 v134, v138, v139
    v_mul_f32 v135, v138, v138
    v_fmac_f32 v135, v139, v139
    v_add_f32 v134, v134, v140
    v_fmac_f32 v135, v140, v140
    v_add_f32 v134, v134, v141
    v_fmac_f32 v135, v141, v141
    v_add_f32 v134, v134, v142
    v_fmac_f32 v135, v142, v142
    v_add_f32 v134, v134, v143
    v_fmac_f32 v135, v143, v143
    v_add_f32 v134, v134, v144
    v_fmac_f32 v135, v144, v144
    v_add_f32 v134, v134, v145
    v_fmac_f32 v135, v145, v145
    v_cndmask_b32 v134, 0, v134, vcc
    v_cndmask_b32 v135, 0, v135, vcc
    s_waitcnt vmcnt(28)
    v_lshlrev_b32 v138, 16, v8
    v_add_f32_dpp v134, v134, v134 quad_perm:[1,0,3,2] row_mask:0xf bank_mask:0xf
    v_add_f32_dpp v135, v135, v135 quad_perm:[1,0,3,2] row_mask:0xf bank_mask:0xf
    v_and_b32 v139, 0xffff0000, v8
    v_add_f32_dpp v134, v134, v134 quad_perm:[2,3,0,1] row_mask:0xf bank_mask:0xf
    v_add_f32_dpp v135, v135, v135 quad_perm:[2,3,0,1] row_mask:0xf bank_mask:0xf
    v_lshlrev_b32 v140, 16, v9
    v_add_f32_dpp v134, v134, v134 row_half_mirror row_mask:0xf bank_mask:0xf
    v_add_f32_dpp v135, v135, v135 row_half_mirror row_mask:0xf bank_mask:0xf
    v_and_b32 v141, 0xffff0000, v9
    v_add_f32_dpp v134, v134, v134 row_mirror row_mask:0xf bank_mask:0xf
    v_add_f32_dpp v135, v135, v135 row_mirror row_mask:0xf bank_mask:0xf
    v_mov_b32 v136, v134
    v_mov_b32 v137, v135
    v_lshlrev_b32 v142, 16, v10
    v_permlane16_swap_b32 v134, v136
    v_permlane16_swap_b32 v135, v137
    v_add_f32 v134, v134, v136
    v_add_f32 v135, v135, v137
    v_mov_b32 v136, v134
    v_mov_b32 v137, v135
    v_and_b32 v143, 0xffff0000, v10
    v_permlane32_swap_b32 v134, v136
    v_permlane32_swap_b32 v135, v137
    v_add_f32 v134, v134, v136
    v_add_f32 v135, v135, v137
    v_mul_f32 v134, 0x3b124925, v134
    v_mul_f32 v135, 0x3b124925, v135
    v_fma_f32 v135, -v134, v134, v135
    v_add_f32 v134, s57, v134
    v_max_f32 v135, 0, v135
    v_cvt_pk_bf16_f32 v136, v134, v135
    v_lshlrev_b32 v134, 16, v136
    v_and_b32 v135, 0xffff0000, v136
    v_add_f32 v135, 0x3727c5ac, v135
    v_cvt_pk_bf16_f32 v135, v135, v135
    v_and_b32 v135, 0xffff0000, v135
    v_sqrt_f32 v135, v135
    v_lshlrev_b32 v144, 16, v11
    v_cvt_pk_bf16_f32 v135, v135, v135
    v_and_b32 v135, 0xffff0000, v135
    v_rcp_f32 v135, v135
    v_and_b32 v145, 0xffff0000, v11
    v_lshlrev_b32 v146, 16, v12
    v_and_b32 v147, 0xffff0000, v12
    v_lshlrev_b32 v148, 16, v13
    v_and_b32 v149, 0xffff0000, v13
    v_lshlrev_b32 v150, 16, v14
    v_and_b32 v151, 0xffff0000, v14
    v_sub_f32 v138, v138, v134
    v_sub_f32 v139, v139, v134
    v_sub_f32 v140, v140, v134
    v_sub_f32 v141, v141, v134
    v_sub_f32 v142, v142, v134
    v_sub_f32 v143, v143, v134
    v_sub_f32 v144, v144, v134
    v_sub_f32 v145, v145, v134
    v_sub_f32 v146, v146, v134
    v_sub_f32 v147, v147, v134
    v_sub_f32 v148, v148, v134
    v_sub_f32 v149, v149, v134
    v_sub_f32 v150, v150, v134
    v_sub_f32 v151, v151, v134
    v_cvt_pk_bf16_f32 v8, v138, v139
    v_cvt_pk_bf16_f32 v9, v140, v141
    v_cvt_pk_bf16_f32 v10, v142, v143
    v_cvt_pk_bf16_f32 v11, v144, v145
    v_cvt_pk_bf16_f32 v12, v146, v147
    v_cvt_pk_bf16_f32 v13, v148, v149
    v_cvt_pk_bf16_f32 v14, v150, v151
    v_lshlrev_b32 v138, 16, v8
    v_and_b32 v139, 0xffff0000, v8
    v_lshlrev_b32 v140, 16, v9
    v_and_b32 v141, 0xffff0000, v9
    v_lshlrev_b32 v142, 16, v10
    v_and_b32 v143, 0xffff0000, v10
    v_lshlrev_b32 v144, 16, v11
    v_and_b32 v145, 0xffff0000, v11
    v_lshlrev_b32 v146, 16, v12
    v_and_b32 v147, 0xffff0000, v12
    v_lshlrev_b32 v148, 16, v13
    v_and_b32 v149, 0xffff0000, v13
    v_lshlrev_b32 v150, 16, v14
    v_and_b32 v151, 0xffff0000, v14
    v_mul_f32 v138, v138, v135
    v_mul_f32 v139, v139, v135
    v_mul_f32 v140, v140, v135
    v_mul_f32 v141, v141, v135
    v_mul_f32 v142, v142, v135
    v_mul_f32 v143, v143, v135
    v_mul_f32 v144, v144, v135
    v_mul_f32 v145, v145, v135
    v_mul_f32 v146, v146, v135
    v_mul_f32 v147, v147, v135
    v_mul_f32 v148, v148, v135
    v_mul_f32 v149, v149, v135
    v_mul_f32 v150, v150, v135
    v_mul_f32 v151, v151, v135
    v_cvt_pk_bf16_f32 v138, v138, v138
    v_cvt_pk_bf16_f32 v139, v139, v139
    v_cvt_pk_bf16_f32 v140, v140, v140
    v_cvt_pk_bf16_f32 v141, v141, v141
    v_cvt_pk_bf16_f32 v142, v142, v142
    v_cvt_pk_bf16_f32 v143, v143, v143
    v_cvt_pk_bf16_f32 v144, v144, v144
    v_cvt_pk_bf16_f32 v145, v145, v145
    v_cvt_pk_bf16_f32 v146, v146, v146
    v_cvt_pk_bf16_f32 v147, v147, v147
    v_cvt_pk_bf16_f32 v148, v148, v148
    v_cvt_pk_bf16_f32 v149, v149, v149
    v_cvt_pk_bf16_f32 v150, v150, v150
    v_cvt_pk_bf16_f32 v151, v151, v151
    s_waitcnt lgkmcnt(0)
    s_add_u32 s32, s32, 1
    s_and_b32 s31, s32, 1023
    s_and_b32 s33, s32, 15
    s_lshr_b32 s58, s3, 0
    s_and_b32 s58, s58, 16
    s_or_b32 s48, s33, s58
    s_lshr_b32 s58, s3, 1
    s_and_b32 s58, s58, 16
    s_or_b32 s49, s33, s58
    s_lshr_b32 s58, s3, 2
    s_and_b32 s58, s58, 16
    s_or_b32 s50, s33, s58
    s_lshr_b32 s58, s3, 3
    s_and_b32 s58, s58, 16
    s_or_b32 s51, s33, s58
    v_and_b32 v4, v138, v128
    v_and_b32 v5, v138, v129
    v_and_b32 v6, v138, v130
    v_and_b32 v7, v138, v131
    v_and_b32 v8, v139, v128
    v_and_b32 v9, v139, v129
    v_and_b32 v10, v139, v130
    v_and_b32 v11, v139, v131
    s_waitcnt vmcnt(27)
    v_mfma_f32_16x16x32_bf16 v[12:15], v[4:7], v[16:19], 0
    v_and_b32 v4, v140, v128
    v_and_b32 v5, v140, v129
    v_and_b32 v6, v140, v130
    v_and_b32 v7, v140, v131
    s_waitcnt vmcnt(26)
    v_mfma_f32_16x16x32_bf16 v[12:15], v[8:11], v[20:23], v[12:15]
    v_and_b32 v8, v141, v128
    v_and_b32 v9, v141, v129
    v_and_b32 v10, v141, v130
    v_and_b32 v11, v141, v131
    s_waitcnt vmcnt(25)
    v_mfma_f32_16x16x32_bf16 v[12:15], v[4:7], v[24:27], v[12:15]
    v_and_b32 v4, v142, v128
    v_and_b32 v5, v142, v129
    v_and_b32 v6, v142, v130
    v_and_b32 v7, v142, v131
    s_waitcnt vmcnt(24)
    v_mfma_f32_16x16x32_bf16 v[12:15], v[8:11], v[28:31], v[12:15]
    v_and_b32 v8, v143, v128
    v_and_b32 v9, v143, v129
    v_and_b32 v10, v143, v130
    v_and_b32 v11, v143, v131
    s_waitcnt vmcnt(23)
    v_mfma_f32_16x16x32_bf16 v[12:15], v[4:7], v[32:35], v[12:15]
    v_and_b32 v4, v144, v128
    v_and_b32 v5, v144, v129
    v_and_b32 v6, v144, v130
    v_and_b32 v7, v144, v131
    s_waitcnt vmcnt(22)
    v_mfma_f32_16x16x32_bf16 v[12:15], v[8:11], v[36:39], v[12:15]
    v_and_b32 v8, v145, v128
    v_and_b32 v9, v145, v129
    v_and_b32 v10, v145, v130
    v_and_b32 v11, v145, v131
    s_waitcnt vmcnt(21)
    v_mfma_f32_16x16x32_bf16 v[12:15], v[4:7], v[40:43], v[12:15]
    v_and_b32 v4, v146, v128
    v_and_b32 v5, v146, v129
    v_and_b32 v6, v146, v130
    v_and_b32 v7, v146, v131
    s_waitcnt vmcnt(20)
    v_mfma_f32_16x16x32_bf16 v[12:15], v[8:11], v[44:47], v[12:15]
    v_and_b32 v8, v147, v128
    v_and_b32 v9, v147, v129
    v_and_b32 v10, v147, v130
    v_and_b32 v11, v147, v131
    s_waitcnt vmcnt(19)
    v_mfma_f32_16x16x32_bf16 v[12:15], v[4:7], v[48:51], v[12:15]
    v_and_b32 v4, v148, v128
    v_and_b32 v5, v148, v129
    v_and_b32 v6, v148, v130
    v_and_b32 v7, v148, v131
    s_waitcnt vmcnt(18)
    v_mfma_f32_16x16x32_bf16 v[12:15], v[8:11], v[52:55], v[12:15]
    v_and_b32 v8, v149, v128
    v_and_b32 v9, v149, v129
    v_and_b32 v10, v149, v130
    v_and_b32 v11, v149, v131
    s_waitcnt vmcnt(17)
    v_mfma_f32_16x16x32_bf16 v[12:15], v[4:7], v[56:59], v[12:15]
    v_and_b32 v4, v150, v128
    v_and_b32 v5, v150, v129
    v_and_b32 v6, v150, v130
    v_and_b32 v7, v150, v131
    s_waitcnt vmcnt(16)
    v_mfma_f32_16x16x32_bf16 v[12:15], v[8:11], v[60:63], v[12:15]
    v_and_b32 v8, v151, v128
    v_and_b32 v9, v151, v129
    v_and_b32 v10, v151, v130
    v_and_b32 v11, v151, v131
    s_waitcnt vmcnt(15)
    v_mfma_f32_16x16x32_bf16 v[12:15], v[4:7], v[64:67], v[12:15]
    s_waitcnt vmcnt(14)
    v_mfma_f32_16x16x32_bf16 v[12:15], v[8:11], v[68:71], v[12:15]
    v_mov_b32 v136, 0xffffffe0
    s_nop 6
    v_mov_b32 v4, v12
    v_mov_b32 v5, v13
    v_mov_b32 v6, v14
    v_mov_b32 v7, v15
    v_permlane32_swap_b32 v12, v4
    v_permlane32_swap_b32 v13, v5
    v_permlane32_swap_b32 v14, v6
    v_permlane32_swap_b32 v15, v7
    v_add_f32_dpp v12, v4, v12 row_ror:8 row_mask:0xf bank_mask:0xf
    v_add_f32_dpp v13, v5, v13 row_ror:8 row_mask:0xf bank_mask:0xf
    v_add_f32_dpp v14, v6, v14 row_ror:8 row_mask:0xf bank_mask:0xf
    v_add_f32_dpp v15, v7, v15 row_ror:8 row_mask:0xf bank_mask:0xf
    v_add_u32 v12, 16, v12
    v_add_u32 v13, 16, v13
    v_add_u32 v14, 16, v14
    v_add_u32 v15, 16, v15
    v_and_or_b32 v12, v12, v136, s48
    v_and_or_b32 v13, v13, v136, s49
    v_and_or_b32 v14, v14, v136, s50
    v_and_or_b32 v15, v15, v136, s51
    s_mov_b64 exec, 0x00ff00ff
    buffer_store_dwordx4 v[12:15], v133, s[36:39], s55 offen
    s_mov_b64 exec, -1
    v_mov_b32 v56, v12
    v_mov_b32 v57, v13
    v_mov_b32 v58, v14
    v_mov_b32 v59, v15
    v_add_u32 v60, s55, v133
    v_add_u32 v61, s65, v133
    v_and_b32 v4, v138, v128
    v_and_b32 v5, v138, v129
    v_and_b32 v6, v138, v130
    v_and_b32 v7, v138, v131
    v_and_b32 v8, v139, v128
    v_and_b32 v9, v139, v129
    v_and_b32 v10, v139, v130
    v_and_b32 v11, v139, v131
    s_waitcnt vmcnt(14)
    v_mfma_f32_16x16x32_bf16 v[12:15], v[4:7], v[72:75], 0
    v_and_b32 v4, v140, v128
    v_and_b32 v5, v140, v129
    v_and_b32 v6, v140, v130
    v_and_b32 v7, v140, v131
    s_waitcnt vmcnt(13)
    v_mfma_f32_16x16x32_bf16 v[12:15], v[8:11], v[76:79], v[12:15]
    v_and_b32 v8, v141, v128
    v_and_b32 v9, v141, v129
    v_and_b32 v10, v141, v130
    v_and_b32 v11, v141, v131
    s_waitcnt vmcnt(12)
    v_mfma_f32_16x16x32_bf16 v[12:15], v[4:7], v[80:83], v[12:15]
    v_and_b32 v4, v142, v128
    v_and_b32 v5, v142, v129
    v_and_b32 v6, v142, v130
    v_and_b32 v7, v142, v131
    s_waitcnt vmcnt(11)
    v_mfma_f32_16x16x32_bf16 v[12:15], v[8:11], v[84:87], v[12:15]
    v_and_b32 v8, v143, v128
    v_and_b32 v9, v143, v129
    v_and_b32 v10, v143, v130
    v_and_b32 v11, v143, v131
    s_waitcnt vmcnt(10)
    v_mfma_f32_16x16x32_bf16 v[12:15], v[4:7], v[88:91], v[12:15]
    v_and_b32 v4, v144, v128
    v_and_b32 v5, v144, v129
    v_and_b32 v6, v144, v130
    v_and_b32 v7, v144, v131
    s_waitcnt vmcnt(9)
    v_mfma_f32_16x16x32_bf16 v[12:15], v[8:11], v[92:95], v[12:15]
    v_and_b32 v8, v145, v128
    v_and_b32 v9, v145, v129
    v_and_b32 v10, v145, v130
    v_and_b32 v11, v145, v131
    s_waitcnt vmcnt(8)
    v_mfma_f32_16x16x32_bf16 v[12:15], v[4:7], v[96:99], v[12:15]
    v_and_b32 v4, v146, v128
    v_and_b32 v5, v146, v129
    v_and_b32 v6, v146, v130
    v_and_b32 v7, v146, v131
    s_waitcnt vmcnt(7)
    v_mfma_f32_16x16x32_bf16 v[12:15], v[8:11], v[100:103], v[12:15]
    v_and_b32 v8, v147, v128
    v_and_b32 v9, v147, v129
    v_and_b32 v10, v147, v130
    v_and_b32 v11, v147, v131
    s_waitcnt vmcnt(6)
    v_mfma_f32_16x16x32_bf16 v[12:15], v[4:7], v[104:107], v[12:15]
    v_and_b32 v4, v148, v128
    v_and_b32 v5, v148, v129
    v_and_b32 v6, v148, v130
    v_and_b32 v7, v148, v131
    s_waitcnt vmcnt(5)
    v_mfma_f32_16x16x32_bf16 v[12:15], v[8:11], v[108:111], v[12:15]
    v_and_b32 v8, v149, v128
    v_and_b32 v9, v149, v129
    v_and_b32 v10, v149, v130
    v_and_b32 v11, v149, v131
    s_waitcnt vmcnt(4)
    v_mfma_f32_16x16x32_bf16 v[12:15], v[4:7], v[112:115], v[12:15]
    v_and_b32 v4, v150, v128
    v_and_b32 v5, v150, v129
    v_and_b32 v6, v150, v130
    v_and_b32 v7, v150, v131
    s_waitcnt vmcnt(3)
    v_mfma_f32_16x16x32_bf16 v[12:15], v[8:11], v[116:119], v[12:15]
    v_and_b32 v8, v151, v128
    v_and_b32 v9, v151, v129
    v_and_b32 v10, v151, v130
    v_and_b32 v11, v151, v131
    s_waitcnt vmcnt(2)
    v_mfma_f32_16x16x32_bf16 v[12:15], v[4:7], v[120:123], v[12:15]
    s_waitcnt vmcnt(1)
    v_mfma_f32_16x16x32_bf16 v[12:15], v[8:11], v[124:127], v[12:15]
    v_mov_b32 v136, 0xffffffe0
    s_nop 6
    v_mov_b32 v4, v12
    v_mov_b32 v5, v13
    v_mov_b32 v6, v14
    v_mov_b32 v7, v15
    v_permlane32_swap_b32 v12, v4
    v_permlane32_swap_b32 v13, v5
    v_permlane32_swap_b32 v14, v6
    v_permlane32_swap_b32 v15, v7
    v_add_f32_dpp v12, v4, v12 row_ror:8 row_mask:0xf bank_mask:0xf
    v_add_f32_dpp v13, v5, v13 row_ror:8 row_mask:0xf bank_mask:0xf
    v_add_f32_dpp v14, v6, v14 row_ror:8 row_mask:0xf bank_mask:0xf
    v_add_f32_dpp v15, v7, v15 row_ror:8 row_mask:0xf bank_mask:0xf
    v_add_u32 v12, 16, v12
    v_add_u32 v13, 16, v13
    v_add_u32 v14, 16, v14
    v_add_u32 v15, 16, v15
    v_and_or_b32 v12, v12, v136, s48
    v_and_or_b32 v13, v13, v136, s49
    v_and_or_b32 v14, v14, v136, s50
    v_and_or_b32 v15, v15, v136, s51
    s_mov_b64 exec, 0x00ff00ff
    buffer_store_dwordx4 v[12:15], v133, s[36:39], s65 offen
    s_mov_b64 exec, -1
    v_and_b32 v62, 0xf0, v2
    s_and_b32 s59, s29, 24
    s_lshl_b32 s65, s59, 5
    s_add_u32 s65, s65, s64
    s_add_u32 s65, s65, 8192
    s_lshl_b32 s59, s59, 6
    s_add_u32 s58, s28, 16
    s_lshl_b32 s58, s58, 11
    s_add_u32 s59, s59, s58
    s_lshl_b32 s55, s28, 16
    s_add_u32 s55, s55, s59
    s_add_u32 s55, s55, 1310720
    s_and_b32 s58, s58, 0xe000
    s_add_u32 s67, s59, s58
    s_add_u32 s67, s67, 1835008
    v_and_b32 v133, 0xc0, v2
    v_add_u32 v133, v133, v62
    v_and_b32 v136, 16, v0
    v_lshl_add_u32 v133, v136, 9, v133
    v_and_b32 v136, 32, v0
    v_lshl_add_u32 v133, v136, 12, v133
    s_and_b32 s53, s29, 7
    s_cmp_eq_u32 s53, 2
    s_cselect_b32 s53, 1, 0
    s_cmp_eq_u32 s28, 7
    s_cselect_b32 s53, 0, s53
    s_waitcnt vmcnt(1)
    s_mov_b32 s62, 0
    s_branch L_q_top_41
L_q_retry_42:
    s_add_u32 s62, s62, 1
    s_cmp_ge_u32 s62, 1048576
    s_cbranch_scc1 L_q_ok_43
L_q_top_41:
    s_cmp_eq_u32 s62, 3
    s_cbranch_scc1 L_cb_45
L_cbj_46:
    s_mov_b32 s58, s64
    s_add_u32 s59, s58, 4096
    buffer_load_dwordx4 v[16:19], v2, s[36:39], s58 offen offset:0 sc1
    buffer_load_dwordx4 v[20:23], v2, s[36:39], s58 offen offset:1024 sc1
    buffer_load_dwordx4 v[24:27], v2, s[36:39], s58 offen offset:2048 sc1
    buffer_load_dwordx4 v[28:31], v2, s[36:39], s58 offen offset:3072 sc1
    buffer_load_dwordx4 v[32:35], v2, s[36:39], s59 offen offset:0 sc1
    buffer_load_dwordx4 v[36:39], v2, s[36:39], s59 offen offset:1024 sc1
    buffer_load_dwordx4 v[40:43], v2, s[36:39], s59 offen offset:2048 sc1
    buffer_load_dwordx4 v[44:47], v2, s[36:39], s59 offen offset:3072 sc1
    s_waitcnt vmcnt(0)
    v_xor_b32 v16, s48, v16
    v_xor_b32 v17, s49, v17
    v_xor_b32 v18, s50, v18
    v_xor_b32 v19, s51, v19
    v_or3_b32 v134, v16, v17, v18
    v_or_b32 v134, v134, v19
    v_xor_b32 v20, s48, v20
    v_xor_b32 v21, s49, v21
    v_xor_b32 v22, s50, v22
    v_xor_b32 v23, s51, v23
    v_or3_b32 v134, v134, v20, v21
    v_or3_b32 v134, v134, v22, v23
    v_xor_b32 v24, s48, v24
    v_xor_b32 v25, s49, v25
    v_xor_b32 v26, s50, v26
    v_xor_b32 v27, s51, v27
    v_or3_b32 v134, v134, v24, v25
    v_or3_b32 v134, v134, v26, v27
    v_xor_b32 v28, s48, v28
    v_xor_b32 v29, s49, v29
    v_xor_b32 v30, s50, v30
    v_xor_b32 v31, s51, v31
    v_or3_b32 v134, v134, v28, v29
    v_or3_b32 v134, v134, v30, v31
    v_xor_b32 v32, s48, v32
    v_xor_b32 v33, s49, v33
    v_xor_b32 v34, s50, v34
    v_xor_b32 v35, s51, v35
    v_or3_b32 v134, v134, v32, v33
    v_or3_b32 v134, v134, v34, v35
    v_xor_b32 v36, s48, v36
    v_xor_b32 v37, s49, v37
    v_xor_b32 v38, s50, v38
    v_xor_b32 v39, s51, v39
    v_or3_b32 v134, v134, v36, v37
    v_or3_b32 v134, v134, v38, v39
    v_xor_b32 v40, s48, v40
    v_xor_b32 v41, s49, v41
    v_xor_b32 v42, s50, v42
    v_xor_b32 v43, s51, v43
    v_or3_b32 v134, v134, v40, v41
    v_or3_b32 v134, v134, v42, v43
    v_xor_b32 v44, s48, v44
    v_xor_b32 v45, s49, v45
    v_xor_b32 v46, s50, v46
    v_xor_b32 v47, s51, v47
    v_or3_b32 v134, v134, v44, v45
    v_or3_b32 v134, v134, v46, v47
    v_and_b32 v136, 15, v134
    v_cmp_ne_u32 vcc, 0, v136
    s_cbranch_vccnz L_q_retry_42
L_q_ok_43:
    v_and_b32 v134, 31, v134
    v_cmp_ne_u32 vcc, 0, v134
    s_cmp_eq_u64 vcc, 0
    s_cselect_b32 s63, 1, 0
    s_cbranch_scc0 L_cf_47
L_cfj_48:
    s_cmp_eq_u32 s53, 0
    s_cbranch_scc1 L_nh_49
    s_add_u32 s56, s65, 4096
    buffer_load_dwordx4 v[72:75], v62, s[36:39], s65 offen offset:0 sc1
    buffer_load_dwordx4 v[76:79], v62, s[36:39], s65 offen offset:1024 sc1
    buffer_load_dwordx4 v[80:83], v62, s[36:39], s65 offen offset:2048 sc1
    buffer_load_dwordx4 v[84:87], v62, s[36:39], s65 offen offset:3072 sc1
    buffer_load_dwordx4 v[88:91], v62, s[36:39], s56 offen offset:0 sc1
    buffer_load_dwordx4 v[92:95], v62, s[36:39], s56 offen offset:1024 sc1
    buffer_load_dwordx4 v[96:99], v62, s[36:39], s56 offen offset:2048 sc1
    buffer_load_dwordx4 v[100:103], v62, s[36:39], s56 offen offset:3072 sc1
L_nh_49:
    v_add_f32 v16, v16, v24
    v_add_f32 v32, v32, v40
    v_add_f32 v17, v17, v25
    v_add_f32 v33, v33, v41
    v_add_f32 v18, v18, v26
    v_add_f32 v34, v34, v42
    v_add_f32 v19, v19, v27
    v_add_f32 v35, v35, v43
    v_add_f32 v16, v16, v32
    v_add_f32 v17, v17, v33
    v_add_f32 v18, v18, v34
    v_add_f32 v19, v19, v35
    v_cvt_pk_bf16_f32 v16, v16, v17
    v_cvt_pk_bf16_f32 v17, v18, v19
    v_add_f32 v20, v20, v28
    v_add_f32 v36, v36, v44
    v_add_f32 v21, v21, v29
    v_add_f32 v37, v37, v45
    v_add_f32 v22, v22, v30
    v_add_f32 v38, v38, v46
    v_add_f32 v23, v23, v31
    v_add_f32 v39, v39, v47
    v_add_f32 v20, v20, v36
    v_add_f32 v21, v21, v37
    v_add_f32 v22, v22, v38
    v_add_f32 v23, v23, v39
    v_cvt_pk_bf16_f32 v20, v20, v21
    v_cvt_pk_bf16_f32 v21, v22, v23
    v_mov_b32 v136, s63
    v_mov_b32 v137, s32
    v_mov_b32 v3, 0
    v_lshlrev_b32 v2, 3, v0
    ds_write_b64 v2, v[16:17] offset:0
    ds_write_b64 v2, v[20:21] offset:512
    s_waitcnt lgkmcnt(0)
    ds_write_b64 v3, v[136:137] offset:1152
    v_and_b32 v2, 0x78, v2
    v_lshlrev_b32 v32, 6, v0
    v_mov_b32 v33, s31
    s_mov_b32 s61, 1035512379
    s_lshl_b32 s58, s28, 10
    s_lshl_b32 s59, s29, 4
    s_add_u32 s58, s58, s59
    s_add_u32 s58, s58, 196608
    s_mov_b32 s62, 0
L_ml_50:
    ds_read_b64 v[24:25], v2 offset:1024
    s_add_u32 s62, s62, 1
    s_cmp_ge_u32 s62, 8388608
    s_waitcnt lgkmcnt(0)
    v_cmp_gt_f32 vcc, 0, v25
    s_cbranch_scc1 L_mlo_51
    s_cbranch_vccnz L_ml_50
L_mlo_51:
    v_max_f32_dpp v28, v24, v24 quad_perm:[1,0,3,2] row_mask:0xf bank_mask:0xf
    s_nop 1
    v_max_f32_dpp v28, v28, v28 quad_perm:[2,3,0,1] row_mask:0xf bank_mask:0xf
    s_nop 1
    v_max_f32_dpp v28, v28, v28 row_half_mirror row_mask:0xf bank_mask:0xf
    v_sub_f32 v24, v24, v28
    v_mul_f32 v24, s61, v24
    v_exp_f32 v24, v24
    v_and_or_b32 v28, v28, s60, v33
    v_mul_f32 v29, v25, v24
    v_mov_b32 v30, v28
    s_nop 0
    v_add_f32_dpp v29, v29, v29 quad_perm:[1,0,3,2] row_mask:0xf bank_mask:0xf
    s_nop 1
    v_add_f32_dpp v29, v29, v29 quad_perm:[2,3,0,1] row_mask:0xf bank_mask:0xf
    s_nop 1
    v_add_f32_dpp v29, v29, v29 row_half_mirror row_mask:0xf bank_mask:0xf
    v_and_or_b32 v29, v29, s60, v33
    v_mov_b32 v31, v29
    s_mov_b64 exec, 0x101
    s_cmp_eq_u32 s63, 1
    s_cbranch_scc0 L_ps_52
    buffer_store_dwordx4 v[28:31], v32, s[36:39], s58 offen
L_pj_53:
    s_mov_b64 exec, -1
    s_cmp_eq_u32 s53, 0
    s_cbranch_scc1 L_wt
    v_mov_b32 v132, 1
    v_mov_b32 v135, s31
    s_mov_b32 s54, 0xffff0000
    s_mov_b32 s62, 0
    s_waitcnt vmcnt(1)
    s_branch L_g_chk_57
L_g_retry_55:
    s_add_u32 s62, s62, 1
    s_cmp_ge_u32 s62, 1048576
    s_cbranch_scc1 L_g_ok_56
L_g_top_54:
    s_add_u32 s56, s65, 4096
    buffer_load_dwordx4 v[72:75], v62, s[36:39], s65 offen offset:0 sc1
    buffer_load_dwordx4 v[76:79], v62, s[36:39], s65 offen offset:1024 sc1
    buffer_load_dwordx4 v[80:83], v62, s[36:39], s65 offen offset:2048 sc1
    buffer_load_dwordx4 v[84:87], v62, s[36:39], s65 offen offset:3072 sc1
    buffer_load_dwordx4 v[88:91], v62, s[36:39], s56 offen offset:0 sc1
    buffer_load_dwordx4 v[92:95], v62, s[36:39], s56 offen offset:1024 sc1
    buffer_load_dwordx4 v[96:99], v62, s[36:39], s56 offen offset:2048 sc1
    buffer_load_dwordx4 v[100:103], v62, s[36:39], s56 offen offset:3072 sc1
    s_waitcnt vmcnt(0)
L_g_chk_57:
    v_xor_b32 v72, s48, v72
    v_xor_b32 v73, s49, v73
    v_xor_b32 v74, s50, v74
    v_xor_b32 v75, s51, v75
    v_or3_b32 v134, v72, v73, v74
    v_or_b32 v134, v134, v75
    v_xor_b32 v76, s48, v76
    v_xor_b32 v77, s49, v77
    v_xor_b32 v78, s50, v78
    v_xor_b32 v79, s51, v79
    v_or3_b32 v134, v134, v76, v77
    v_or3_b32 v134, v134, v78, v79
    v_xor_b32 v80, s48, v80
    v_xor_b32 v81, s49, v81
    v_xor_b32 v82, s50, v82
    v_xor_b32 v83, s51, v83
    v_or3_b32 v134, v134, v80, v81
    v_or3_b32 v134, v134, v82, v83
    v_xor_b32 v84, s48, v84
    v_xor_b32 v85, s49, v85
    v_xor_b32 v86, s50, v86
    v_xor_b32 v87, s51, v87
    v_or3_b32 v134, v134, v84, v85
    v_or3_b32 v134, v134, v86, v87
    v_xor_b32 v88, s48, v88
    v_xor_b32 v89, s49, v89
    v_xor_b32 v90, s50, v90
    v_xor_b32 v91, s51, v91
    v_or3_b32 v134, v134, v88, v89
    v_or3_b32 v134, v134, v90, v91
    v_xor_b32 v92, s48, v92
    v_xor_b32 v93, s49, v93
    v_xor_b32 v94, s50, v94
    v_xor_b32 v95, s51, v95
    v_or3_b32 v134, v134, v92, v93
    v_or3_b32 v134, v134, v94, v95
    v_xor_b32 v96, s48, v96
    v_xor_b32 v97, s49, v97
    v_xor_b32 v98, s50, v98
    v_xor_b32 v99, s51, v99
    v_or3_b32 v134, v134, v96, v97
    v_or3_b32 v134, v134, v98, v99
    v_xor_b32 v100, s48, v100
    v_xor_b32 v101, s49, v101
    v_xor_b32 v102, s50, v102
    v_xor_b32 v103, s51, v103
    v_or3_b32 v134, v134, v100, v101
    v_or3_b32 v134, v134, v102, v103
    v_and_b32 v136, 15, v134
    v_cmp_ne_u32 vcc, 0, v136
    s_cbranch_vccnz L_g_retry_55
L_g_ok_56:
    s_mov_b32 s58, 4294967264
    v_and_b32 v72, s58, v72
    v_and_b32 v73, s58, v73
    v_and_b32 v74, s58, v74
    v_and_b32 v75, s58, v75
    v_and_b32 v76, s58, v76
    v_and_b32 v77, s58, v77
    v_and_b32 v78, s58, v78
    v_and_b32 v79, s58, v79
    v_and_b32 v80, s58, v80
    v_and_b32 v81, s58, v81
    v_and_b32 v82, s58, v82
    v_and_b32 v83, s58, v83
    v_and_b32 v84, s58, v84
    v_and_b32 v85, s58, v85
    v_and_b32 v86, s58, v86
    v_and_b32 v87, s58, v87
    v_and_b32 v88, s58, v88
    v_and_b32 v89, s58, v89
    v_and_b32 v90, s58, v90
    v_and_b32 v91, s58, v91
    v_and_b32 v92, s58, v92
    v_and_b32 v93, s58, v93
    v_and_b32 v94, s58, v94
    v_and_b32 v95, s58, v95
    v_and_b32 v96, s58, v96
    v_and_b32 v97, s58, v97
    v_and_b32 v98, s58, v98
    v_and_b32 v99, s58, v99
    v_and_b32 v100, s58, v100
    v_and_b32 v101, s58, v101
    v_and_b32 v102, s58, v102
    v_and_b32 v103, s58, v103
    v_add_f32 v72, v72, v76
    v_add_f32 v80, v80, v84
    v_add_f32 v73, v73, v77
    v_add_f32 v81, v81, v85
    v_add_f32 v74, v74, v78
    v_add_f32 v82, v82, v86
    v_add_f32 v75, v75, v79
    v_add_f32 v83, v83, v87
    v_add_f32 v72, v72, v80
    v_add_f32 v73, v73, v81
    v_add_f32 v74, v74, v82
    v_add_f32 v75, v75, v83
    v_add_f32 v88, v88, v92
    v_add_f32 v96, v96, v100
    v_add_f32 v89, v89, v93
    v_add_f32 v97, v97, v101
    v_add_f32 v90, v90, v94
    v_add_f32 v98, v98, v102
    v_add_f32 v91, v91, v95
    v_add_f32 v99, v99, v103
    v_add_f32 v88, v88, v96
    v_add_f32 v89, v89, v97
    v_add_f32 v90, v90, v98
    v_add_f32 v91, v91, v99
    v_cvt_pk_bf16_f32 v76, v72, v88
    v_cvt_pk_bf16_f32 v77, v73, v89
    v_cvt_pk_bf16_f32 v78, v74, v90
    v_cvt_pk_bf16_f32 v79, v75, v91
    v_lshlrev_b32 v72, 16, v76
    v_and_b32 v88, 0xffff0000, v76
    v_lshlrev_b32 v73, 16, v77
    v_and_b32 v89, 0xffff0000, v77
    v_lshlrev_b32 v74, 16, v78
    v_and_b32 v90, 0xffff0000, v78
    v_lshlrev_b32 v75, 16, v79
    v_and_b32 v91, 0xffff0000, v79
    v_max_f32 v72, 0, v72
    v_max_f32 v73, 0, v73
    v_max_f32 v74, 0, v74
    v_max_f32 v75, 0, v75
    v_mul_f32 v72, v72, v88
    v_mul_f32 v73, v73, v89
    v_mul_f32 v74, v74, v90
    v_mul_f32 v75, v75, v91
    v_cvt_pk_bf16_f32 v72, v72, v72
    v_cvt_pk_bf16_f32 v73, v73, v73
    v_cvt_pk_bf16_f32 v74, v74, v74
    v_cvt_pk_bf16_f32 v75, v75, v75
    v_and_or_b32 v72, v72, s54, v135
    v_and_or_b32 v73, v73, s54, v135
    v_and_or_b32 v74, v74, s54, v135
    v_and_or_b32 v75, v75, s54, v135
    buffer_store_dwordx4 v[72:75], v133, s[36:39], s67 offen sc1
    s_mov_b64 exec, 0xffff
    s_cmp_eq_u32 s63, 1
    s_cbranch_scc0 L_ps_58
    buffer_store_dwordx4 v[72:75], v133, s[36:39], s55 offen
L_pj_59:
    s_mov_b64 exec, 1
    ds_add_u32 v3, v132 offset:1164
    s_mov_b64 exec, -1
L_wt:
    s_setprio 1
    v_lshlrev_b32 v2, 4, v0
    s_lshl_b32 s58, s28, 10
    s_add_u32 s58, s58, 196608
    s_mov_b32 s62, 0
L_lw_60:
    ds_read_b32 v136, v3 offset:1160
    s_add_u32 s62, s62, 1
    s_cmp_ge_u32 s62, 8388608
    s_waitcnt lgkmcnt(0)
    v_cmp_gt_u32 vcc, 0xbf800001, v136
    s_cbranch_scc1 L_lwok_61
    s_cbranch_vccz L_lwok_61
    s_sleep 1
    s_branch L_lw_60
L_lwok_61:
    s_mov_b32 s62, 0
    s_branch L_wm_top_62
L_wm_retry_63:
    s_add_u32 s62, s62, 1
    s_cmp_ge_u32 s62, 1048576
    s_cbranch_scc1 L_wm_ok_64
L_wm_top_62:
    buffer_load_dwordx4 v[16:19], v2, s[36:39], s58 offen sc1
    ds_read_b32 v137, v3 offset:1168
    s_waitcnt lgkmcnt(0)
    v_readfirstlane_b32 s59, v137
    s_cmp_lt_u32 s59, 24
    s_cbranch_scc1 L_exit
    s_waitcnt vmcnt(0)
    v_xor_b32 v16, s31, v16
    v_xor_b32 v17, s31, v17
    v_xor_b32 v18, s31, v18
    v_xor_b32 v19, s31, v19
    v_or3_b32 v134, v16, v17, v18
    v_or_b32 v134, v134, v19
    v_and_b32 v134, 1023, v134
    v_cmp_ne_u32 vcc, 0, v134
    s_cbranch_vccnz L_wm_retry_63
L_wm_ok_64:
    v_max_f32_dpp v20, v16, v16 quad_perm:[1,0,3,2] row_mask:0xf bank_mask:0xf
    s_nop 1
    v_max_f32_dpp v20, v20, v20 quad_perm:[2,3,0,1] row_mask:0xf bank_mask:0xf
    s_nop 1
    v_max_f32_dpp v20, v20, v20 row_half_mirror row_mask:0xf bank_mask:0xf
    s_nop 1
    v_max_f32_dpp v20, v20, v20 row_mirror row_mask:0xf bank_mask:0xf
    v_mov_b32 v136, v20
    s_nop 1
    v_permlane16_swap_b32 v20, v136
    v_max_f32 v20, v20, v136
    v_sub_f32 v16, v16, v20
    v_mul_f32 v16, s61, v16
    v_exp_f32 v16, v16
    v_lshlrev_b32 v2, 2, v0
    v_mul_f32 v20, v16, v17
    s_nop 1
    v_add_f32_dpp v20, v20, v20 quad_perm:[1,0,3,2] row_mask:0xf bank_mask:0xf
    s_nop 1
    v_add_f32_dpp v20, v20, v20 quad_perm:[2,3,0,1] row_mask:0xf bank_mask:0xf
    s_nop 1
    v_add_f32_dpp v20, v20, v20 row_half_mirror row_mask:0xf bank_mask:0xf
    s_nop 1
    v_add_f32_dpp v20, v20, v20 row_mirror row_mask:0xf bank_mask:0xf
    v_mov_b32 v136, v20
    s_nop 1
    v_permlane16_swap_b32 v20, v136
    v_add_f32 v20, v20, v136
    v_rcp_f32 v20, v20
    s_nop 0
    v_mul_f32 v16, v16, v20
    ds_write_b32 v2, v16 offset:1280
    s_waitcnt lgkmcnt(0)
    s_endpgm
L_h1m:
    s_mov_b64 exec, -1
    s_barrier
    s_mov_b32 s50, L_code_end-L_pc
    s_mov_b32 s51, 0x20000
    s_movk_i32 s54, 8192
    buffer_load_dword v4, v2, s[48:51], s54 offen offset:192
    s_waitcnt lgkmcnt(0)
    s_load_dword s32, s[26:27], 0
    s_mov_b32 s36, s26
    s_mov_b32 s37, s27
    s_mov_b32 s38, 2097152
    s_mov_b32 s39, 0x20000
    s_mov_b32 s60, 4294966272
    s_lshr_b32 s54, s29, 2
    s_lshl_b32 s59, s28, 2
    s_add_u32 s59, s59, s54
    s_lshl_b32 s59, s59, 11
    s_add_u32 s52, s59, 262144
    s_add_u32 s53, s52, 1024
    s_and_b32 s55, s29, 0x13
    s_cmp_eq_u32 s28, 7
    s_cselect_b32 s55, 1, s55
    s_lshl_b32 s59, s28, 14
    s_lshl_b32 s57, s29, 9
    s_add_u32 s59, s59, s57
    s_add_u32 s59, s59, 1042432
    v_mov_b32 v5, s59
    s_cmp_eq_u32 s55, 0
    s_cselect_b32 s64, s53, 2097152
    s_cselect_b32 s65, s52, 2097152
    s_lshl_b32 s58, s28, 5
    s_add_u32 s58, s58, s29
    s_lshl_b32 s59, s58, 11
    s_add_u32 s59, s59, 524288
    s_lshl_b32 s58, s58, 11
    s_add_u32 s58, s58, 1310720
    s_lshr_b32 s66, s29, 1
    s_sub_u32 s57, s29, 16
    s_cmp_lt_u32 s29, 16
    s_cselect_b32 s66, s66, s57
    s_cmp_eq_u32 s66, s28
    s_cselect_b32 s58, s58, 2097152
    s_mov_b32 s66, 2097152
    s_sub_u32 s57, s66, 0
    v_mov_b32 v6, s57
    v_cmp_gt_u32 vcc, 48, v0
    s_nop 1
    v_cndmask_b32 v5, v5, v6, vcc
    s_sub_u32 s57, s64, 5120
    v_mov_b32 v6, s57
    v_cmp_gt_u32 vcc, 44, v0
    s_nop 1
    v_cndmask_b32 v5, v5, v6, vcc
    s_sub_u32 s57, s65, 4096
    v_mov_b32 v6, s57
    v_cmp_gt_u32 vcc, 40, v0
    s_nop 1
    v_cndmask_b32 v5, v5, v6, vcc
    s_sub_u32 s57, s58, 2048
    v_mov_b32 v6, s57
    v_cmp_gt_u32 vcc, 32, v0
    s_nop 1
    v_cndmask_b32 v5, v5, v6, vcc
    s_sub_u32 s57, s59, 0
    v_mov_b32 v6, s57
    v_cmp_gt_u32 vcc, 16, v0
    s_nop 1
    v_cndmask_b32 v5, v5, v6, vcc
    s_lshl_b32 s59, s28, 10
    s_lshl_b32 s57, s29, 5
    s_add_u32 s59, s59, s57
    s_add_u32 s59, s59, 189952
    v_mov_b32 v6, s59
    v_cmp_eq_u32 vcc, 52, v0
    s_nop 1
    v_cndmask_b32 v5, v5, v6, vcc
    v_add_u32 v5, v5, v2
    s_mov_b32 exec_lo, 0
    s_mov_b32 exec_hi, 0x1f0000
    buffer_load_dword v6, v5, s[36:39], 0 offen sc1
    s_mov_b64 exec, -1
    v_lshlrev_b32 v2, 4, v0
    v_and_b32 v1, 3, v0
    v_lshrrev_b32 v3, 4, v0
    v_lshl_add_u32 v1, v3, 2, v1
    v_lshlrev_b32 v25, 1, v1
    s_lshl_b32 s56, s28, 7
    s_lshl_b32 s57, s54, 5
    s_add_u32 s56, s56, s57
    s_mov_b32 s40, s4
    s_mov_b32 s41, s5
    s_mov_b32 s42, 896
    s_mov_b32 s43, 0x20000
    buffer_load_ushort v27, v25, s[40:43], s56 offen
    s_mov_b32 s48, s22
    s_mov_b32 s49, s23
    s_mov_b32 s50, 896
    s_mov_b32 s51, 0x20000
    s_waitcnt lgkmcnt(0)
    s_add_u32 s32, s32, 1
    s_and_b32 s31, s32, 1023
    s_lshl_b32 s16, s28, 7
    s_add_u32 s16, s16, 6144
    s_mov_b32 s17, 0
    s_load_dword s59, s[26:27], s16
    s_and_b32 s57, s2, 63
    s_lshr_b32 s58, s2, 6
    s_lshl_b32 s57, s57, 7
    s_lshl_b32 s58, s58, 14
    s_add_u32 s57, s57, s58
    s_and_b32 s58, s29, 1
    s_lshl_b32 s58, s58, 13
    s_add_u32 s57, s57, s58
    s_add_u32 s57, s57, 65536
    s_mov_b32 s18, 0
    s_mov_b32 s62, 0
    s_waitcnt lgkmcnt(0)
L_pr_67:
    s_mov_b32 s58, 0
    s_load_dword s59, s[26:27], s57
L_pw_68:
    s_getreg_b32 s66, hwreg(HW_REG_IB_STS, 8, 4)
    s_add_u32 s58, s58, 1
    s_cmp_ge_u32 s58, 64
    s_cselect_b32 s66, 0, s66
    s_cmp_lg_u32 s66, 0
    s_cbranch_scc1 L_pw_68
    s_waitcnt lgkmcnt(0)
    s_sub_u32 s59, 0, s58
    s_bitcmp1_b32 s57, 13
    s_cselect_b32 s58, s59, s58
    s_add_u32 s18, s18, s58
    s_xor_b32 s57, s57, 0x2000
    s_add_u32 s62, s62, 1
    s_cmp_lt_u32 s62, 2
    s_cbranch_scc1 L_pr_67
    s_min_i32 s18, s18, 8
    s_max_i32 s18, s18, -8
    s_atomic_add s18, s[26:27], s16
L_np_69:
    s_waitcnt vmcnt(0)
    v_lshlrev_b32 v27, 16, v27
    v_mov_b32 v3, 0
    v_mov_b32 v20, 1
    s_lshl_b32 s57, s28, 7
    s_add_u32 s57, s57, 4096
    v_and_b32 v21, 7, v0
    v_lshlrev_b32 v21, 3, v21
    s_mov_b32 s62, 0
L_tt_70:
    s_sleep 1
    ds_read_b32 v28, v21 offset:1028
    s_add_u32 s62, s62, 1
    s_cmp_ge_u32 s62, 8388608
    s_cbranch_scc1 L_to_71
    s_waitcnt lgkmcnt(0)
    v_cmp_gt_f32 vcc, 0, v28
    s_bcnt1_i32_b64 s58, vcc
    s_cmp_gt_u32 s58, 0
    s_cbranch_scc1 L_tt_70
L_to_71:
    buffer_load_dword v26, v3, s[36:39], s16 offen sc1
    s_mov_b32 exec_hi, 0xfff
    buffer_load_dword v6, v5, s[36:39], 0 offen sc1
    s_mov_b32 exec_hi, -1
    ds_read_b64 v[22:23], v3 offset:1152
    s_waitcnt lgkmcnt(0)
    v_readfirstlane_b32 s63, v22
    s_mov_b64 exec, 1
    s_cmp_eq_u32 s63, 1
    s_cbranch_scc0 L_as_72
    s_mov_b32 s58, 1
    s_atomic_add s58, s[26:27], s57 glc
    s_waitcnt lgkmcnt(0)
    v_mov_b32 v20, s58
L_aj_73:
    v_and_b32 v20, 31, v20
    ds_write_b32 v3, v20 offset:1168
    s_waitcnt vmcnt(0)
    v_readfirstlane_b32 s14, v26
    s_sub_u32 s14, s14, s17
    s_cmp_gt_i32 s14, 0
    s_cselect_b32 s15, 0x2000, 0
    v_mov_b32 v21, s15
    ds_write_b32 v3, v21 offset:1176
    s_mov_b64 exec, -1
    s_cmp_lg_u32 s55, 0
    s_cbranch_scc1 L_exitw
    s_mov_b32 s62, 0
L_lw_74:
    ds_read_b32 v28, v3 offset:1164
    s_add_u32 s62, s62, 1
    s_cmp_ge_u32 s62, 8388608
    s_waitcnt lgkmcnt(0)
    v_cmp_gt_u32 vcc, 0xbf800002, v28
    s_cbranch_scc1 L_lwok_75
    s_cbranch_vccz L_lwok_75
    s_sleep 4
    s_branch L_lw_74
L_lwok_75:
    s_setprio 3
    s_mov_b32 s62, 0
    s_branch L_y_top_76
L_y_retry_77:
    s_sleep 1
    s_add_u32 s62, s62, 1
    s_cmp_ge_u32 s62, 1048576
    s_cbranch_scc1 L_y_ok_78
L_y_top_76:
    v_mov_b32 v12, s31
    v_mov_b32 v13, s31
    v_mov_b32 v14, s31
    v_mov_b32 v15, s31
    s_mov_b64 exec, 0x0fffffff
    buffer_load_dwordx4 v[12:15], v2, s[36:39], s53 offen sc1
    s_mov_b64 exec, -1
    s_waitcnt vmcnt(0)
    v_xor_b32 v12, s31, v12
    v_xor_b32 v13, s31, v13
    v_xor_b32 v14, s31, v14
    v_xor_b32 v15, s31, v15
    v_or3_b32 v28, v12, v13, v14
    v_or_b32 v28, v28, v15
    v_and_b32 v28, 1023, v28
    v_cmp_ne_u32 vcc, 0, v28
    s_cbranch_vccnz L_y_retry_77
L_y_ok_78:
    buffer_load_dwordx4 v[32:35], v2, s[36:39], s52 offen sc1
    v_permlane32_swap_b32 v12, v14
    v_permlane32_swap_b32 v13, v15
    v_add_f32 v12, v12, v14
    v_add_f32 v13, v13, v15
    s_nop 1
    v_permlane16_swap_b32 v12, v13
    v_add_f32 v12, v12, v13
    s_nop 1
    v_add_f32_dpp v12, v12, v12 row_ror:8 row_mask:0xf bank_mask:0xf
    s_nop 1
    v_add_f32_dpp v12, v12, v12 row_ror:4 row_mask:0xf bank_mask:0xf
    v_cvt_pk_bf16_f32 v12, v12, v12
    v_and_b32 v12, 0xffff0000, v12
    v_mul_f32 v13, 0xbfb8aa3b, v12
    v_exp_f32 v13, v13
    s_nop 0
    v_add_f32 v13, 1.0, v13
    v_rcp_f32 v13, v13
    s_nop 0
    v_mul_f32 v12, v12, v13
    v_cvt_pk_bf16_f32 v12, v12, v12
    v_and_b32 v12, 0xffff0000, v12
    buffer_load_dwordx4 v[36:39], v2, s[36:39], s52 offen sc1
    s_mov_b32 s62, 0
L_s_top_80:
    s_waitcnt vmcnt(1)
    v_xor_b32 v8, s31, v32
    v_xor_b32 v9, s31, v33
    v_xor_b32 v10, s31, v34
    v_xor_b32 v11, s31, v35
    v_or3_b32 v28, v8, v9, v10
    v_bitop3_b32 v28, v28, v11, s60 bitop3:0x54
    v_cmp_ne_u32 vcc, 0, v28
    s_cbranch_vccz L_s_ok_81
    buffer_load_dwordx4 v[32:35], v2, s[36:39], s52 offen sc1
    s_waitcnt vmcnt(1)
    v_xor_b32 v8, s31, v36
    v_xor_b32 v9, s31, v37
    v_xor_b32 v10, s31, v38
    v_xor_b32 v11, s31, v39
    v_or3_b32 v28, v8, v9, v10
    v_bitop3_b32 v28, v28, v11, s60 bitop3:0x54
    v_cmp_ne_u32 vcc, 0, v28
    s_cbranch_vccz L_s_ok_81
    buffer_load_dwordx4 v[36:39], v2, s[36:39], s52 offen sc1
    s_add_u32 s62, s62, 1
    s_cmp_lt_u32 s62, 1048576
    s_cbranch_scc1 L_s_top_80
L_s_ok_81:
    v_permlane32_swap_b32 v8, v10
    v_permlane32_swap_b32 v9, v11
    v_add_f32 v8, v8, v10
    v_add_f32 v9, v9, v11
    s_nop 1
    v_permlane16_swap_b32 v8, v9
    v_add_f32 v8, v8, v9
    s_nop 1
    v_add_f32_dpp v8, v8, v8 row_ror:8 row_mask:0xf bank_mask:0xf
    s_nop 1
    v_add_f32_dpp v8, v8, v8 row_ror:4 row_mask:0xf bank_mask:0xf
    v_cvt_pk_bf16_f32 v8, v8, v8
    v_and_b32 v8, 0xffff0000, v8
    v_mul_f32 v8, v8, v12
    v_cvt_pk_bf16_f32 v8, v8, v8
    v_and_b32 v8, 0xffff0000, v8
    v_add_f32 v8, v8, v27
    v_cvt_pk_bf16_f32 v8, v8, v8
    s_mov_b32 exec_lo, 0x000f000f
    s_mov_b32 exec_hi, 0x000f000f
    buffer_store_short v8, v25, s[48:51], s56 offen
    s_cmp_lg_u32 s2, 2
    s_cbranch_scc1 L_exit
    s_mov_b64 exec, 1
    v_mov_b32 v1, s32
    v_mov_b32 v2, 0
    buffer_store_dword v1, v2, s[36:39], 0 offen
    s_endpgm
L_exitw:
    s_waitcnt lgkmcnt(0)
L_exit:
L_end:
    s_endpgm
L_ps_17:
    buffer_store_dwordx4 v[36:39], v130, s[36:39], s64 offen sc1
    s_branch L_pj_18
L_ps_29:
    buffer_store_dword v36, v133, s[36:39], s67 offen sc1
    s_branch L_pj_30
L_ps_37:
    buffer_store_dword v4, v135, s[36:39], s18 offen sc1
    s_branch L_pj_38
L_cb_45:
    s_mov_b64 exec, 0x00ff00ff
    buffer_store_dwordx4 v[56:59], v60, s[36:39], 0 offen sc1
    buffer_store_dwordx4 v[12:15], v61, s[36:39], 0 offen sc1
    s_mov_b64 exec, -1
    s_branch L_cbj_46
L_cf_47:
    s_mov_b64 exec, 0x00ff00ff
    buffer_store_dwordx4 v[56:59], v60, s[36:39], 0 offen sc1
    buffer_store_dwordx4 v[12:15], v61, s[36:39], 0 offen sc1
    s_mov_b64 exec, -1
    v_and_b32 v16, 0xffffffe0, v16
    v_and_b32 v17, 0xffffffe0, v17
    v_and_b32 v18, 0xffffffe0, v18
    v_and_b32 v19, 0xffffffe0, v19
    v_and_b32 v20, 0xffffffe0, v20
    v_and_b32 v21, 0xffffffe0, v21
    v_and_b32 v22, 0xffffffe0, v22
    v_and_b32 v23, 0xffffffe0, v23
    v_and_b32 v24, 0xffffffe0, v24
    v_and_b32 v25, 0xffffffe0, v25
    v_and_b32 v26, 0xffffffe0, v26
    v_and_b32 v27, 0xffffffe0, v27
    v_and_b32 v28, 0xffffffe0, v28
    v_and_b32 v29, 0xffffffe0, v29
    v_and_b32 v30, 0xffffffe0, v30
    v_and_b32 v31, 0xffffffe0, v31
    v_and_b32 v32, 0xffffffe0, v32
    v_and_b32 v33, 0xffffffe0, v33
    v_and_b32 v34, 0xffffffe0, v34
    v_and_b32 v35, 0xffffffe0, v35
    v_and_b32 v36, 0xffffffe0, v36
    v_and_b32 v37, 0xffffffe0, v37
    v_and_b32 v38, 0xffffffe0, v38
    v_and_b32 v39, 0xffffffe0, v39
    v_and_b32 v40, 0xffffffe0, v40
    v_and_b32 v41, 0xffffffe0, v41
    v_and_b32 v42, 0xffffffe0, v42
    v_and_b32 v43, 0xffffffe0, v43
    v_and_b32 v44, 0xffffffe0, v44
    v_and_b32 v45, 0xffffffe0, v45
    v_and_b32 v46, 0xffffffe0, v46
    v_and_b32 v47, 0xffffffe0, v47
    s_branch L_cfj_48
L_ps_52:
    buffer_store_dwordx4 v[28:31], v32, s[36:39], s58 offen sc1
    s_branch L_pj_53
L_ps_58:
    buffer_store_dwordx4 v[72:75], v133, s[36:39], s55 offen sc1
    s_branch L_pj_59
L_as_72:
    v_mov_b32 v24, s57
    global_atomic_add v20, v24, v20, s[26:27] sc0 sc1
    s_waitcnt vmcnt(0)
    s_branch L_aj_73
L_code_end:
.section .rodata,"a"
.p2align 6
.amdhsa_kernel recurrent_scan__sliding_block_cached__glu_gated_reglu__decode_kernel
  .amdhsa_next_free_vgpr 156
  .amdhsa_next_free_sgpr 80
  .amdhsa_accum_offset 156
  .amdhsa_group_segment_fixed_size 0
  .amdhsa_kernarg_size 96
  .amdhsa_user_sgpr_count 2
  .amdhsa_user_sgpr_kernarg_segment_ptr 1
  .amdhsa_system_sgpr_workgroup_id_x 1
.end_amdhsa_kernel
```
